```python
import torch

def _softmax(x, axis=-1):
    return torch.softmax(x, dim=axis)
def _gelu(x):
    return torch.nn.functional.gelu(x, approximate="tanh")
def _silu(x):
    return torch.nn.functional.silu(x)
def _sigmoid(x):
    return torch.sigmoid(x)
def _layernorm(x, axis=-1, eps=1e-5):
    m = x.mean(dim=axis, keepdim=True)
    v = x.var(dim=axis, keepdim=True, unbiased=False)
    return (x - m) / torch.sqrt(v + eps)
def _scatter_add(tgt, idx, src, axis=0):
    return tgt.clone().index_add_(axis, idx, src)
def _segment_sum(src, seg, n):
    out = torch.zeros((n,) + src.shape[1:], dtype=src.dtype)
    return out.index_add_(0, seg, src)
def _pad(x, pw):
    flat = tuple(v for pair in reversed(pw) for v in pair)
    return torch.nn.functional.pad(x, flat)

kernel_name = 'gather_scatter__edge_featured_mpnn_gatedgcn__graph'

def setup_inputs():

    _w = (lambda a: (lambda t: t.to(torch.bfloat16) if t.is_floating_point() else t)(torch.as_tensor(a)))
    N, deg, D, De = 12500, 32, 128, max(4, 1)
    E = N * deg
    return {
        "x": _w((lambda *s: torch.randn(*s, dtype=torch.bfloat16) * 0.4)(N, D)),
        "e_attr": _w((lambda *s: torch.randn(*s, dtype=torch.bfloat16) * 0.8)(E, De)),
        "src": _w((lambda lo, hi, *s: torch.randint(lo, hi, s))(0, N, E).to(torch.int64)),
        "dst": _w((lambda lo, hi, *s: torch.randint(lo, hi, s))(0, N, E).to(torch.int64)),
        "w_a": _w((lambda *s: torch.randn(*s, dtype=torch.bfloat16) * 0.4)(D, D)),
        "w_b": _w((lambda *s: torch.randn(*s, dtype=torch.bfloat16) * 0.4)(D, D)),
        "w_c": _w((lambda *s: torch.randn(*s, dtype=torch.bfloat16) * 0.8)(De, D)),
        "w_u": _w((lambda *s: torch.randn(*s, dtype=torch.bfloat16) * 0.05)(D, D)),
        "w_v": _w((lambda *s: torch.randn(*s, dtype=torch.bfloat16) * 0.05)(D, D)),
    }

def reference(x, e_attr, src, dst, w_a, w_b, w_c, w_u, w_v):
    N, D = x.shape
    hv = x @ w_v
    g = x[dst] @ w_a + x[src] @ w_b + e_attr @ w_c
    eta = _sigmoid(g)
    denom = _segment_sum(eta, dst, N) + 1e-6
    eta_n = eta / denom[dst]
    agg = _segment_sum(eta_n * hv[src], dst, N)
    z = x @ w_u + agg
    relu_z = torch.where(z > 0, z, 0 * z)
    return x + relu_z
```

```asm
; @launch grid=(256,1,1) block=(1024,1,1) lds=163328
.amdgcn_target "amdgcn-amd-amdhsa--gfx950"
.text
.globl gather_scatter__edge_featured_mpnn_gatedgcn__graph_kernel
.p2align 8
.type gather_scatter__edge_featured_mpnn_gatedgcn__graph_kernel,@function
gather_scatter__edge_featured_mpnn_gatedgcn__graph_kernel:
    s_cmp_ge_u32 s2, 256
    s_cbranch_scc1 KF_END
    s_xor_b32 s2, s2, 128
    s_load_dwordx16 s[4:19], s[0:1], 0
    s_load_dwordx8 s[20:27], s[0:1], 64
    v_lshrrev_b32 v1, 6, v0
    v_lshlrev_b32 v4, 4, v0
    v_readfirstlane_b32 s3, v1
    s_and_b32 s28, s2, 1
    s_bfe_u32 s29, s2, 0x20001
    s_lshl_b32 s29, s29, 4
    s_bfe_u32 s30, s2, 0x40003
    s_add_u32 s83, s29, s30
    s_mul_i32 s82, s83, 50176
    s_lshr_b32 s30, s2, 7
    s_lshl_b32 s29, s83, 1
    s_add_u32 s29, s29, s30
    s_mul_i32 s31, s30, 100
    s_lshl_b32 s84, s30, 2
    s_lshr_b32 s30, s82, 8
    s_add_u32 s30, s30, s31
    s_sub_u32 s84, 100, s84
    s_sub_u32 s31, 12500, s30
    s_min_u32 s31, s31, s84
    v_cmp_gt_u32 vcc, 782, v0
    s_mov_b64 s[86:87], vcc
    v_cmp_gt_u32 vcc, 781, v0
    s_mov_b64 s[88:89], vcc
    v_lshlrev_b32 v47, 5, v0
    s_mul_i32 s97, s2, 12500
    s_mul_i32 s98, s2, 25000
    s_lshl_b32 s99, s28, 7
    s_lshl_b32 s81, s3, 10
    v_and_b32 v1, 63, v0
    v_lshlrev_b32 v40, 2, v1
    v_lshlrev_b32 v39, 3, v1
    v_mov_b32 v42, 0
    v_mov_b32 v43, 0
    v_mov_b32 v41, 1
    v_lshrrev_b32 v7, 4, v0
    v_xor_b32 v5, v0, v7
    v_and_b32 v5, 15, v5
    v_lshlrev_b32 v5, 4, v5
    v_lshl_add_u32 v5, v7, 8, v5
    v_lshrrev_b32 v8, 3, v0
    v_and_b32 v9, 2, v8
    v_and_b32 v10, 4, v7
    v_or_b32 v9, v9, v10
    v_and_b32 v10, 7, v0
    v_xor_b32 v9, v9, v10
    v_lshlrev_b32 v9, 4, v9
    v_lshl_add_u32 v38, v8, 8, v9
    s_cmp_lg_u32 s3, 1
    s_cbranch_scc1 KF_NOZ0
    ds_write_b32 v40, v42 offset:0
    ds_write_b32 v40, v42 offset:256
    ds_write_b32 v40, v42 offset:512
    ds_write_b32 v40, v42 offset:768
    ds_write_b32 v40, v42 offset:1024
    v_add_u32 v10, 163072, v40
    ds_write_b32 v10, v42
KF_NOZ0:
    s_bitcmp1_b32 s2, 7
    s_waitcnt lgkmcnt(0)
    s_cbranch_scc1 KF_NP0
    s_mov_b32 s64, s10
    s_mov_b32 s65, s11
    s_mov_b32 s66, 1600000
    s_mov_b32 s67, 0x00020000
    s_mov_b64 exec, s[86:87]
    buffer_load_dwordx4 v[80:83], v4, s[64:67], s97 offen
    s_mov_b64 exec, -1
    s_add_u32 s40, s26, 16777216
    s_addc_u32 s41, s27, 0
    s_mov_b32 s42, 4964352
    s_mov_b32 s43, 0x00020000
    s_cmp_lt_u32 s3, 13
    s_cbranch_scc1 KF_P_NOPF
    ds_write_b64 v39, v[42:43] offset:38912
    s_cmp_eq_u32 s3, 15
    s_cbranch_scc1 KF_P_NOPF
    s_and_b32 s85, s2, 0xf4
    s_cmp_lg_u32 s85, 0
    s_cbranch_scc1 KF_P_NOPF
    s_lshr_b32 s85, s2, 1
    s_and_b32 s84, s2, 3
    s_and_b32 s85, s85, 4
    s_or_b32 s85, s85, s84
    s_lshl_b32 s85, s85, 1
    s_add_u32 s85, s85, s3
    s_sub_u32 s85, s85, 13
    s_lshl_b32 s84, s85, 12
    s_add_u32 s84, s84, 4898816
    s_lshl_b32 s85, s85, 12
    v_mov_b32 v44, 0
    v_mov_b32 v45, 0
    v_lshlrev_b32 v9, 4, v1
    v_lshlrev_b32 v10, 7, v1
    buffer_store_dwordx4 v[42:45], v9, s[40:43], s85 offen offset:0 sc1
    buffer_store_dwordx4 v[42:45], v9, s[40:43], s85 offen offset:1024 sc1
    buffer_store_dwordx4 v[42:45], v9, s[40:43], s85 offen offset:2048 sc1
    buffer_store_dwordx4 v[42:45], v9, s[40:43], s85 offen offset:3072 sc1
    s_bfm_b64 exec, 32, 0
    buffer_store_dword v42, v10, s[40:43], s84 offen sc1
    s_mov_b64 exec, -1
KF_P_NOPF:
    s_mov_b32 s68, s8
    s_mov_b32 s69, s9
    s_mov_b32 s70, 1600000
    s_mov_b32 s71, 0x00020000
    s_mov_b32 s72, s6
    s_mov_b32 s73, s7
    s_mov_b32 s74, 3200000
    s_mov_b32 s75, 0x00020000
    s_waitcnt lgkmcnt(0)
    s_barrier
    s_cmp_gt_u32 s3, 12
    s_cbranch_scc1 KF_P_NOE
    s_mov_b64 exec, s[86:87]
    buffer_load_dwordx4 v[84:87], v4, s[68:71], s97 offen
    buffer_load_dwordx4 v[88:91], v47, s[72:75], s98 offen
    buffer_load_dwordx4 v[92:95], v47, s[72:75], s98 offen offset:16
    s_mov_b64 exec, -1
KF_P_NOE:
    s_mov_b32 s48, s4
    s_mov_b32 s49, s5
    s_mov_b32 s50, 3200000
    s_mov_b32 s51, 0x00020000
    s_mov_b32 s36, s12
    s_mov_b32 s37, s13
    s_mov_b32 s38, 32768
    s_mov_b32 s39, 0x00020000
    s_mov_b32 s76, s18
    s_mov_b32 s77, s19
    s_mov_b32 s78, 32768
    s_mov_b32 s79, 0x00020000
    s_mov_b32 s95, 1
    s_cmp_lt_u32 s3, 7
    s_cselect_b32 s80, 0, 1
    s_cselect_b32 s96, 0, 7
    s_sub_u32 s96, s3, s96
    s_mov_b32 s46, 8
    s_mov_b32 s94, 7
    s_mov_b32 s47, 40960
    s_mov_b32 s93, 73728
    s_mov_b32 s85, 0
    s_branch KF_COMMON
KF_NP0:
    s_mov_b32 s64, s14
    s_mov_b32 s65, s15
    s_mov_b32 s66, 32768
    s_mov_b32 s67, 0x00020000
    s_add_u32 m0, s81, 1280
    s_nop 0
    buffer_load_dwordx4 v38, s[64:67], s99 offen lds
    s_mov_b32 s68, s20
    s_mov_b32 s69, s21
    s_mov_b32 s70, 32768
    s_mov_b32 s71, 0x00020000
    s_add_u32 m0, s81, 17664
    s_nop 0
    buffer_load_dwordx4 v38, s[68:71], s99 offen lds
    s_mov_b32 s72, s12
    s_mov_b32 s73, s13
    s_mov_b32 s74, 32768
    s_mov_b32 s75, 0x00020000
    s_add_u32 m0, s81, 34048
    s_nop 0
    buffer_load_dwordx4 v38, s[72:75], s99 offen lds
    s_mov_b32 s76, s18
    s_mov_b32 s77, s19
    s_mov_b32 s78, 32768
    s_mov_b32 s79, 0x00020000
    s_add_u32 m0, s81, 50432
    s_nop 0
    buffer_load_dwordx4 v38, s[76:79], s99 offen lds
    s_barrier
    s_mov_b32 s48, s4
    s_mov_b32 s49, s5
    s_mov_b32 s50, 3200000
    s_mov_b32 s51, 0x00020000
    s_mul_i32 s88, s3, 3
    s_lshl_b32 s97, s3, 1
    s_add_u32 s97, s97, 5
    s_cmp_lt_u32 s3, 5
    s_cselect_b32 s88, s88, s97
    s_cselect_b32 s89, 3, 2
    s_lshl_b32 s97, s3, 2
    s_sub_u32 s97, s97, 15
    s_cmp_lt_u32 s3, 10
    s_cselect_b32 s88, s88, s97
    s_cselect_b32 s89, s89, 4
    v_and_b32 v5, 0x3ff, v5
    s_xor_b32 s97, s88, s3
    s_and_b32 s97, s97, 3
    s_lshl_b32 s97, s97, 6
    v_xor_b32 v100, s97, v5
    s_lshl_b32 s97, s88, 10
    s_add_u32 m0, s97, 66816
    s_add_u32 s97, s97, s82
    buffer_load_dwordx4 v100, s[48:51], s97 offen lds
    s_add_u32 s88, s88, 1
    s_xor_b32 s97, s88, s3
    s_and_b32 s97, s97, 3
    s_lshl_b32 s97, s97, 6
    v_xor_b32 v101, s97, v5
    s_lshl_b32 s97, s88, 10
    s_add_u32 m0, s97, 66816
    s_add_u32 s97, s97, s82
    buffer_load_dwordx4 v101, s[48:51], s97 offen lds
    s_add_u32 s88, s88, 1
    s_cmp_le_u32 s89, 2
    s_cbranch_scc1 KF_NP1A
    s_xor_b32 s97, s88, s3
    s_and_b32 s97, s97, 3
    s_lshl_b32 s97, s97, 6
    v_xor_b32 v102, s97, v5
    s_lshl_b32 s97, s88, 10
    s_add_u32 m0, s97, 66816
    s_add_u32 s97, s97, s82
    buffer_load_dwordx4 v102, s[48:51], s97 offen lds
    s_add_u32 s88, s88, 1
    s_cmp_le_u32 s89, 3
    s_cbranch_scc1 KF_NP1A
    s_xor_b32 s97, s88, s3
    s_and_b32 s97, s97, 3
    s_lshl_b32 s97, s97, 6
    v_xor_b32 v103, s97, v5
    s_lshl_b32 s97, s88, 10
    s_add_u32 m0, s97, 66816
    s_add_u32 s97, s97, s82
    buffer_load_dwordx4 v103, s[48:51], s97 offen lds
    s_add_u32 s88, s88, 1
KF_NP1A:
    s_add_u32 s40, s26, 16777216
    s_addc_u32 s41, s27, 0
    s_mov_b32 s42, 4964352
    s_mov_b32 s43, 0x00020000
    s_mov_b32 s96, 0x43765210
    s_mov_b32 s97, 0xfedcba98
    s_lshl_b32 s98, s3, 2
    s_lshr_b64 s[96:97], s[96:97], s98
    s_and_b32 s39, s96, 15
    s_cmp_lt_u32 s39, 5
    s_cselect_b32 s80, 0, 1
    s_cselect_b32 s96, 0, 5
    s_cmp_lt_u32 s39, 13
    s_cselect_b32 s97, 0, 1
    s_cselect_b32 s98, 10, 13
    s_cmp_lt_u32 s39, 10
    s_cselect_b32 s95, 0, 1
    s_cselect_b32 s80, s80, s97
    s_cselect_b32 s96, s96, s98
    s_cselect_b32 s46, 5, 3
    s_cselect_b32 s94, 13, 6
    s_cselect_b32 s47, 0, 32768
    s_cselect_b32 s85, 0, 100
    s_add_u32 s47, s47, 1280
    s_sub_u32 s96, s39, s96
    s_mov_b32 s93, 66816
KF_COMMON:
    s_mul_i32 s97, s28, 3276800
    s_add_u32 s32, s26, s97
    s_addc_u32 s33, s27, 0
    s_mov_b32 s34, 3276800
    s_mov_b32 s35, 0x00020000
    s_mov_b32 s52, s22
    s_mov_b32 s53, s23
    s_mov_b32 s54, 3200000
    s_mov_b32 s55, 0x00020000
    s_mov_b32 s56, s16
    s_mov_b32 s57, s17
    s_mov_b32 s58, 1024
    s_mov_b32 s59, 0x00020000
    s_mov_b32 s60, s24
    s_mov_b32 s61, s25
    s_mov_b32 s62, 256
    s_mov_b32 s63, 0x00020000
    s_mov_b32 s44, 0x22221111
    s_mov_b32 s45, 0x88884444
    v_and_b32 v2, 15, v1
    v_lshrrev_b32 v3, 4, v1
    s_cmp_eq_u32 s95, 1
    s_cbranch_scc1 KF_G_ADDR_AU
    s_lshl_b32 s97, s39, 11
    s_add_u32 s97, s97, 116992
    v_and_b32 v14, 7, v2
    v_xor_b32 v14, v14, v3
    v_lshl_add_u32 v15, v2, 7, s97
    v_lshl_add_u32 v44, v14, 4, v15
    v_xor_b32 v14, 4, v14
    v_lshl_add_u32 v45, v14, 4, v15
    v_lshrrev_b32 v14, 3, v1
    v_and_b32 v15, 7, v1
    v_lshlrev_b32 v46, 4, v15
    v_lshl_add_u32 v46, v14, 8, v46
    v_xor_b32 v15, v14, v15
    v_lshlrev_b32 v15, 4, v15
    v_lshl_add_u32 v15, v14, 7, v15
    v_add_u32 v47, s97, v15
    s_branch KF_G_ADDR_DONE
KF_G_ADDR_AU:
    s_lshl_b32 s98, s80, 3
    v_xor_b32 v45, v2, v3
    v_xor_b32 v45, s98, v45
    s_lshl_b32 s97, s96, 11
    s_add_u32 s97, s97, 137472
    v_lshl_add_u32 v44, v2, 7, s97
    v_lshl_add_u32 v44, v45, 3, v44
    v_xor_b32 v45, 32, v44
    v_mov_b32 v46, v2
KF_G_ADDR_DONE:
    v_lshrrev_b32 v9, 2, v2
    v_lshrrev_b32 v11, 1, v9
    v_and_b32 v12, 1, v3
    v_lshl_or_b32 v11, v12, 1, v11
    s_lshl_b32 s97, s80, 1
    v_xor_b32 v11, s97, v11
    v_lshl_add_u32 v9, v3, 3, v9
    v_and_b32 v10, 3, v2
    v_lshlrev_b32 v10, 3, v10
    v_lshl_add_u32 v10, v9, 7, v10
    v_add_u32 v10, s47, v10
    v_xor_b32 v12, 1, v11
    v_lshl_add_u32 v11, v11, 5, v10
    v_lshl_add_u32 v12, v12, 5, v10
    s_lshl_b32 s97, s96, 12
    s_add_u32 s97, s97, s93
    v_add_u32 v15, s85, v2
    v_lshl_add_u32 v13, v15, 8, s97
    v_and_b32 v15, 15, v15
    v_add_u32 v14, 0, v3
    v_xor_b32 v14, v14, v15
    v_lshl_add_u32 v7, v14, 4, v13
    v_add_u32 v14, 4, v3
    v_xor_b32 v14, v14, v15
    v_lshl_add_u32 v9, v14, 4, v13
    v_add_u32 v14, 8, v3
    v_xor_b32 v14, v14, v15
    v_lshl_add_u32 v10, v14, 4, v13
    v_add_u32 v14, 12, v3
    v_xor_b32 v14, v14, v15
    v_lshl_add_u32 v13, v14, 4, v13
    s_mov_b32 s90, 0xbfb8aa3b
    s_mov_b32 s91, 0x07060100
    s_mov_b32 s92, 0x07060302
    s_bitcmp1_b32 s2, 7
    s_cbranch_scc1 KF_G_STAGE
    s_cmp_gt_u32 s3, 12
    s_cbranch_scc1 KF_P_HELP2
    v_mov_b32 v51, 163072
    s_mov_b32 s85, 21913099
    s_waitcnt vmcnt(3)
    v_mul_hi_u32 v96, v80, s85
    v_mul_u32_u24 v42, 196, v96
    v_sub_u32 v100, v80, v42
    v_subrev_u32 v42, 100, v100
    v_min_u32 v100, v100, v42
    v_lshrrev_b32 v42, 31, v42
    v_lshl_add_u32 v96, v96, 1, 1
    v_sub_u32 v96, v96, v42
    v_lshlrev_b32 v96, 2, v96
    v_mul_hi_u32 v97, v81, s85
    v_mul_u32_u24 v42, 196, v97
    v_sub_u32 v101, v81, v42
    v_subrev_u32 v42, 100, v101
    v_min_u32 v101, v101, v42
    v_lshrrev_b32 v42, 31, v42
    v_lshl_add_u32 v97, v97, 1, 1
    v_sub_u32 v97, v97, v42
    v_lshlrev_b32 v97, 2, v97
    v_mul_hi_u32 v98, v82, s85
    v_mul_u32_u24 v42, 196, v98
    v_sub_u32 v102, v82, v42
    v_subrev_u32 v42, 100, v102
    v_min_u32 v102, v102, v42
    v_lshrrev_b32 v42, 31, v42
    v_lshl_add_u32 v98, v98, 1, 1
    v_sub_u32 v98, v98, v42
    v_lshlrev_b32 v98, 2, v98
    v_mul_hi_u32 v99, v83, s85
    v_mul_u32_u24 v42, 196, v99
    v_sub_u32 v103, v83, v42
    v_subrev_u32 v42, 100, v103
    v_min_u32 v103, v103, v42
    v_lshrrev_b32 v42, 31, v42
    v_lshl_add_u32 v99, v99, 1, 1
    v_sub_u32 v99, v99, v42
    v_lshlrev_b32 v99, 2, v99
    s_mov_b64 exec, s[86:87]
    ds_add_rtn_u32 v104, v96, v41 offset:38912
    s_mov_b64 exec, s[88:89]
    ds_add_rtn_u32 v105, v97, v41 offset:38912
    ds_add_rtn_u32 v106, v98, v41 offset:38912
    ds_add_rtn_u32 v107, v99, v41 offset:38912
    s_mov_b64 exec, 1
    ds_add_u32 v51, v41 offset:16
    s_mov_b64 exec, -1
KF_SBA:
    ds_read_b32 v50, v51 offset:16
    s_waitcnt lgkmcnt(0)
    v_readfirstlane_b32 s98, v50
    s_cmp_lt_u32 s98, 13
    s_cbranch_scc1 KF_SBA
    ds_read_b64 v[42:43], v39 offset:38912
    s_waitcnt lgkmcnt(0)
    v_add_u32 v49, v42, v43
    s_nop 1
    v_add_u32_dpp v49, v49, v49 row_shr:1 row_mask:0xf bank_mask:0xf bound_ctrl:0
    s_nop 1
    v_add_u32_dpp v49, v49, v49 row_shr:2 row_mask:0xf bank_mask:0xf bound_ctrl:0
    s_nop 1
    v_add_u32_dpp v49, v49, v49 row_shr:4 row_mask:0xf bank_mask:0xf bound_ctrl:0
    s_nop 1
    v_add_u32_dpp v49, v49, v49 row_shr:8 row_mask:0xf bank_mask:0xf bound_ctrl:0
    s_nop 1
    v_add_u32_dpp v49, v49, v49 row_bcast:15 row_mask:0xa bank_mask:0xf
    s_nop 1
    v_add_u32_dpp v49, v49, v49 row_bcast:31 row_mask:0xc bank_mask:0xf
    v_sub_u32 v49, v49, v43
    v_sub_u32 v48, v49, v42
    ds_write_b64 v39, v[48:49] offset:39424
    s_mov_b64 exec, s[86:87]
    ds_read_b32 v80, v96 offset:39424
    s_mov_b64 exec, s[88:89]
    ds_read_b32 v81, v97 offset:39424
    ds_read_b32 v82, v98 offset:39424
    ds_read_b32 v83, v99 offset:39424
    s_mov_b64 exec, -1
    v_lshl_or_b32 v42, v42, 12, v48
    v_or_b32 v42, 0x80000000, v42
    v_lshl_or_b32 v43, v43, 12, v49
    v_or_b32 v43, 0x80000000, v43
    s_waitcnt vmcnt(0)
    s_mov_b32 s97, 1280
    s_waitcnt lgkmcnt(0)
    v_add_u32 v104, v104, v80
    v_mad_u32_u24 v80, v104, 12, s97
    v_lshl_or_b32 v100, v100, 16, v84
    v_add_u32 v105, v105, v81
    v_mad_u32_u24 v81, v105, 12, s97
    v_lshl_or_b32 v101, v101, 16, v85
    v_add_u32 v106, v106, v82
    v_mad_u32_u24 v82, v106, 12, s97
    v_lshl_or_b32 v102, v102, 16, v86
    v_add_u32 v107, v107, v83
    v_mad_u32_u24 v83, v107, 12, s97
    v_lshl_or_b32 v103, v103, 16, v87
    s_mov_b64 exec, s[86:87]
    ds_write2_b32 v80, v88, v89 offset0:0 offset1:1
    ds_write_b32 v80, v100 offset:8
    s_mov_b64 exec, s[88:89]
    ds_write2_b32 v81, v90, v91 offset0:0 offset1:1
    ds_write_b32 v81, v101 offset:8
    ds_write2_b32 v82, v92, v93 offset0:0 offset1:1
    ds_write_b32 v82, v102 offset:8
    ds_write2_b32 v83, v94, v95 offset0:0 offset1:1
    ds_write_b32 v83, v103 offset:8
    s_mov_b64 exec, 1
    ds_add_u32 v51, v41 offset:20
    s_mov_b64 exec, -1
KF_SBB:
    ds_read_b32 v50, v51 offset:20
    s_waitcnt lgkmcnt(0)
    v_readfirstlane_b32 s98, v50
    s_cmp_lt_u32 s98, 13
    s_cbranch_scc1 KF_SBB
    ds_read_b128 v[60:63], v4 offset:1280
    ds_read_b128 v[64:67], v4 offset:14592
    ds_read_b128 v[68:71], v4 offset:27904
    s_mul_i32 s85, s2, 37632
    s_add_u32 s85, s85, 81920
    s_add_u32 s97, s85, 13312
    s_add_u32 s98, s85, 26624
    v_cmp_gt_u32 vcc, 680, v0
    s_waitcnt lgkmcnt(2)
    buffer_store_dwordx4 v[60:63], v4, s[40:43], s85 offen sc1
    s_waitcnt lgkmcnt(1)
    buffer_store_dwordx4 v[64:67], v4, s[40:43], s97 offen sc1
    s_mov_b64 exec, vcc
    s_waitcnt lgkmcnt(0)
    buffer_store_dwordx4 v[68:71], v4, s[40:43], s98 offen sc1
    s_mov_b64 exec, -1
    s_lshl_b32 s85, s2, 9
    s_mov_b64 exec, 1
    v_mov_b32 v48, 163072
    s_waitcnt vmcnt(0)
    ds_add_rtn_u32 v48, v48, v41
    s_mov_b64 exec, -1
    s_waitcnt lgkmcnt(0)
    v_readfirstlane_b32 s98, v48
    s_cmp_lg_u32 s98, 12
    s_cbranch_scc1 KF_P_NOSIG
    buffer_store_dwordx2 v[42:43], v39, s[40:43], s85 offen sc1
    s_branch KF_P_NOSIG
KF_P_HELP2:
    s_sleep 8
    s_cmp_eq_u32 s3, 15
    s_cbranch_scc1 KF_P_HX
    s_cmp_eq_u32 s3, 13
    s_cselect_b32 s64, s36, s76
    s_cselect_b32 s65, s37, s77
    s_mov_b32 s66, 32768
    s_mov_b32 s67, 0x00020000
    s_cselect_b32 s97, 0, 16384
    s_cselect_b32 s98, 64, 0
    s_add_u32 s97, s97, 40960
    v_and_b32 v56, 0x7ff, v38
    v_xor_b32 v56, s98, v56
    v_xor_b32 v57, 64, v56
    s_mov_b32 s98, s99
    s_add_u32 m0, s97, 0
    s_nop 0
    buffer_load_dwordx4 v56, s[64:67], s98 offen lds
    s_add_u32 m0, s97, 1024
    s_add_u32 s98, s98, 2048
    buffer_load_dwordx4 v57, s[64:67], s98 offen lds
    s_add_u32 m0, s97, 2048
    s_add_u32 s98, s98, 2048
    buffer_load_dwordx4 v56, s[64:67], s98 offen lds
    s_add_u32 m0, s97, 3072
    s_add_u32 s98, s98, 2048
    buffer_load_dwordx4 v57, s[64:67], s98 offen lds
    s_add_u32 m0, s97, 4096
    s_add_u32 s98, s98, 2048
    buffer_load_dwordx4 v56, s[64:67], s98 offen lds
    s_add_u32 m0, s97, 5120
    s_add_u32 s98, s98, 2048
    buffer_load_dwordx4 v57, s[64:67], s98 offen lds
    s_add_u32 m0, s97, 6144
    s_add_u32 s98, s98, 2048
    buffer_load_dwordx4 v56, s[64:67], s98 offen lds
    s_add_u32 m0, s97, 7168
    s_add_u32 s98, s98, 2048
    buffer_load_dwordx4 v57, s[64:67], s98 offen lds
    s_add_u32 m0, s97, 8192
    s_add_u32 s98, s98, 2048
    buffer_load_dwordx4 v56, s[64:67], s98 offen lds
    s_add_u32 m0, s97, 9216
    s_add_u32 s98, s98, 2048
    buffer_load_dwordx4 v57, s[64:67], s98 offen lds
    s_add_u32 m0, s97, 10240
    s_add_u32 s98, s98, 2048
    buffer_load_dwordx4 v56, s[64:67], s98 offen lds
    s_add_u32 m0, s97, 11264
    s_add_u32 s98, s98, 2048
    buffer_load_dwordx4 v57, s[64:67], s98 offen lds
    s_add_u32 m0, s97, 12288
    s_add_u32 s98, s98, 2048
    buffer_load_dwordx4 v56, s[64:67], s98 offen lds
    s_add_u32 m0, s97, 13312
    s_add_u32 s98, s98, 2048
    buffer_load_dwordx4 v57, s[64:67], s98 offen lds
    s_add_u32 m0, s97, 14336
    s_add_u32 s98, s98, 2048
    buffer_load_dwordx4 v56, s[64:67], s98 offen lds
    s_add_u32 m0, s97, 15360
    s_add_u32 s98, s98, 2048
    buffer_load_dwordx4 v57, s[64:67], s98 offen lds
    s_and_b32 s85, s2, 0xf4
    s_cmp_lg_u32 s85, 0
    s_cbranch_scc1 KF_P_HW
    s_and_b32 s85, s3, 1
    s_lshl_b32 s85, s85, 7
    s_mov_b64 exec, 1
    s_waitcnt vmcnt(16)
    buffer_atomic_add v41, v40, s[60:63], s85 offen
    s_mov_b64 exec, -1
    s_waitcnt vmcnt(1)
    s_branch KF_P_NOSIG
KF_P_HX:
    v_and_b32 v59, 0x3ff, v5
    v_xor_b32 v56, 192, v59
    v_xor_b32 v57, 128, v59
    v_xor_b32 v58, 64, v59
    s_mov_b32 s98, s82
    s_mov_b32 m0, 73728
    s_nop 0
    buffer_load_dwordx4 v56, s[48:51], s98 offen lds
    s_mov_b32 m0, 74752
    s_add_u32 s98, s98, 1024
    buffer_load_dwordx4 v57, s[48:51], s98 offen lds
    s_mov_b32 m0, 75776
    s_add_u32 s98, s98, 1024
    buffer_load_dwordx4 v58, s[48:51], s98 offen lds
    s_mov_b32 m0, 76800
    s_add_u32 s98, s98, 1024
    buffer_load_dwordx4 v59, s[48:51], s98 offen lds
    s_mov_b32 m0, 77824
    s_add_u32 s98, s98, 1024
    buffer_load_dwordx4 v56, s[48:51], s98 offen lds
    s_mov_b32 m0, 78848
    s_add_u32 s98, s98, 1024
    buffer_load_dwordx4 v57, s[48:51], s98 offen lds
    s_mov_b32 m0, 79872
    s_add_u32 s98, s98, 1024
    buffer_load_dwordx4 v58, s[48:51], s98 offen lds
    s_mov_b32 m0, 80896
    s_add_u32 s98, s98, 1024
    buffer_load_dwordx4 v59, s[48:51], s98 offen lds
    s_mov_b32 m0, 81920
    s_add_u32 s98, s98, 1024
    buffer_load_dwordx4 v56, s[48:51], s98 offen lds
    s_mov_b32 m0, 82944
    s_add_u32 s98, s98, 1024
    buffer_load_dwordx4 v57, s[48:51], s98 offen lds
    s_mov_b32 m0, 83968
    s_add_u32 s98, s98, 1024
    buffer_load_dwordx4 v58, s[48:51], s98 offen lds
    s_mov_b32 m0, 84992
    s_add_u32 s98, s98, 1024
    buffer_load_dwordx4 v59, s[48:51], s98 offen lds
    s_mov_b32 m0, 86016
    s_add_u32 s98, s98, 1024
    buffer_load_dwordx4 v56, s[48:51], s98 offen lds
    s_mov_b32 m0, 87040
    s_add_u32 s98, s98, 1024
    buffer_load_dwordx4 v57, s[48:51], s98 offen lds
    s_mov_b32 m0, 88064
    s_add_u32 s98, s98, 1024
    buffer_load_dwordx4 v58, s[48:51], s98 offen lds
    s_mov_b32 m0, 89088
    s_add_u32 s98, s98, 1024
    buffer_load_dwordx4 v59, s[48:51], s98 offen lds
    s_mov_b32 m0, 90112
    s_add_u32 s98, s98, 1024
    buffer_load_dwordx4 v56, s[48:51], s98 offen lds
    s_mov_b32 m0, 91136
    s_add_u32 s98, s98, 1024
    buffer_load_dwordx4 v57, s[48:51], s98 offen lds
    s_mov_b32 m0, 92160
    s_add_u32 s98, s98, 1024
    buffer_load_dwordx4 v58, s[48:51], s98 offen lds
    s_mov_b32 m0, 93184
    s_add_u32 s98, s98, 1024
    buffer_load_dwordx4 v59, s[48:51], s98 offen lds
    s_mov_b32 m0, 94208
    s_add_u32 s98, s98, 1024
    buffer_load_dwordx4 v56, s[48:51], s98 offen lds
    s_mov_b32 m0, 95232
    s_add_u32 s98, s98, 1024
    buffer_load_dwordx4 v57, s[48:51], s98 offen lds
    s_mov_b32 m0, 96256
    s_add_u32 s98, s98, 1024
    buffer_load_dwordx4 v58, s[48:51], s98 offen lds
    s_mov_b32 m0, 97280
    s_add_u32 s98, s98, 1024
    buffer_load_dwordx4 v59, s[48:51], s98 offen lds
    s_mov_b32 m0, 98304
    s_add_u32 s98, s98, 1024
    buffer_load_dwordx4 v56, s[48:51], s98 offen lds
KF_P_HW:
    s_waitcnt vmcnt(0)
KF_P_NOSIG:
    s_barrier
    s_branch KF_G_GO
KF_G_STAGE:
    v_mov_b32 v1, v44
    v_mov_b32 v2, v45
    v_mov_b32 v3, v46
    v_mov_b32 v14, v47
    s_cmp_eq_u32 s95, 1
    s_cbranch_scc1 KF_G_NOPRN
    s_setprio 3
KF_G_NOPRN:
    v_mov_b32 v4, 163072
    s_cmp_eq_u32 s89, 3
    s_cbranch_scc1 KF_G_W3
    s_cmp_eq_u32 s89, 2
    s_cbranch_scc1 KF_G_W2
    s_waitcnt vmcnt(4)
    s_branch KF_G_W4
KF_G_W3:
    s_waitcnt vmcnt(3)
    s_branch KF_G_W4
KF_G_W2:
    s_waitcnt vmcnt(2)
KF_G_W4:
    s_barrier
    ds_read_b64_tr_b16 v[16:17], v11 offset:0
    ds_read_b64_tr_b16 v[18:19], v11 offset:512
    ds_read_b64_tr_b16 v[20:21], v12 offset:0
    ds_read_b64_tr_b16 v[22:23], v12 offset:512
    ds_read_b64_tr_b16 v[48:49], v11 offset:16384
    ds_read_b64_tr_b16 v[50:51], v11 offset:16896
    ds_read_b64_tr_b16 v[52:53], v12 offset:16384
    ds_read_b64_tr_b16 v[54:55], v12 offset:16896
    ds_read_b64_tr_b16 v[24:25], v11 offset:4096
    ds_read_b64_tr_b16 v[26:27], v11 offset:4608
    ds_read_b64_tr_b16 v[28:29], v12 offset:4096
    ds_read_b64_tr_b16 v[30:31], v12 offset:4608
    ds_read_b64_tr_b16 v[56:57], v11 offset:20480
    ds_read_b64_tr_b16 v[58:59], v11 offset:20992
    ds_read_b64_tr_b16 v[60:61], v12 offset:20480
    ds_read_b64_tr_b16 v[62:63], v12 offset:20992
    ds_read_b64_tr_b16 v[32:33], v11 offset:8192
    ds_read_b64_tr_b16 v[34:35], v11 offset:8704
    ds_read_b64_tr_b16 v[36:37], v12 offset:8192
    ds_read_b64_tr_b16 v[38:39], v12 offset:8704
    ds_read_b64_tr_b16 v[64:65], v11 offset:24576
    ds_read_b64_tr_b16 v[66:67], v11 offset:25088
    ds_read_b64_tr_b16 v[68:69], v12 offset:24576
    ds_read_b64_tr_b16 v[70:71], v12 offset:25088
    ds_read_b64_tr_b16 v[40:41], v11 offset:12288
    ds_read_b64_tr_b16 v[42:43], v11 offset:12800
    ds_read_b64_tr_b16 v[44:45], v12 offset:12288
    ds_read_b64_tr_b16 v[46:47], v12 offset:12800
    ds_read_b64_tr_b16 v[72:73], v11 offset:28672
    ds_read_b64_tr_b16 v[74:75], v11 offset:29184
    ds_read_b64_tr_b16 v[76:77], v12 offset:28672
    ds_read_b64_tr_b16 v[78:79], v12 offset:29184
    s_lshl_b32 s97, s95, 2
    v_add_u32 v5, s97, v4
    s_cmp_eq_u32 s95, 1
    s_cselect_b32 s97, 6, 10
    s_mov_b32 s89, s95
    v_mov_b32 v6, 1
    s_mov_b64 exec, 1
    s_waitcnt vmcnt(0)
    ds_add_u32 v5, v6 offset:16
    s_mov_b64 exec, -1
KF_G_XW:
    s_sleep 2
    ds_read_b32 v6, v5 offset:16
    s_waitcnt lgkmcnt(0)
    v_readfirstlane_b32 s98, v6
    s_cmp_lt_u32 s98, s97
    s_cbranch_scc1 KF_G_XW
    ds_read_b128 v[80:83], v7
    ds_read_b128 v[84:87], v9
    ds_read_b128 v[88:91], v10
    ds_read_b128 v[92:95], v13
    s_branch KF_G_PRE
KF_G_GO:
    v_mov_b32 v1, v44
    v_mov_b32 v2, v45
    v_mov_b32 v3, v46
    v_mov_b32 v14, v47
    s_mov_b32 s89, 1
    s_cmp_ge_u32 s96, 7
    s_cbranch_scc1 KF_G_DONE
    s_cmp_eq_u32 s95, 1
    s_cbranch_scc1 KF_G_NOPRP
    s_setprio 3
KF_G_NOPRP:
KF_G_AUG:
    ds_read_b128 v[80:83], v7
    ds_read_b128 v[84:87], v9
    ds_read_b128 v[88:91], v10
    ds_read_b128 v[92:95], v13
    ds_read_b64_tr_b16 v[16:17], v11 offset:0
    ds_read_b64_tr_b16 v[18:19], v11 offset:512
    ds_read_b64_tr_b16 v[20:21], v12 offset:0
    ds_read_b64_tr_b16 v[22:23], v12 offset:512
    ds_read_b64_tr_b16 v[48:49], v11 offset:16384
    ds_read_b64_tr_b16 v[50:51], v11 offset:16896
    ds_read_b64_tr_b16 v[52:53], v12 offset:16384
    ds_read_b64_tr_b16 v[54:55], v12 offset:16896
    ds_read_b64_tr_b16 v[24:25], v11 offset:4096
    ds_read_b64_tr_b16 v[26:27], v11 offset:4608
    ds_read_b64_tr_b16 v[28:29], v12 offset:4096
    ds_read_b64_tr_b16 v[30:31], v12 offset:4608
    ds_read_b64_tr_b16 v[56:57], v11 offset:20480
    ds_read_b64_tr_b16 v[58:59], v11 offset:20992
    ds_read_b64_tr_b16 v[60:61], v12 offset:20480
    ds_read_b64_tr_b16 v[62:63], v12 offset:20992
    ds_read_b64_tr_b16 v[32:33], v11 offset:8192
    ds_read_b64_tr_b16 v[34:35], v11 offset:8704
    ds_read_b64_tr_b16 v[36:37], v12 offset:8192
    ds_read_b64_tr_b16 v[38:39], v12 offset:8704
    ds_read_b64_tr_b16 v[64:65], v11 offset:24576
    ds_read_b64_tr_b16 v[66:67], v11 offset:25088
    ds_read_b64_tr_b16 v[68:69], v12 offset:24576
    ds_read_b64_tr_b16 v[70:71], v12 offset:25088
    ds_read_b64_tr_b16 v[40:41], v11 offset:12288
    ds_read_b64_tr_b16 v[42:43], v11 offset:12800
    ds_read_b64_tr_b16 v[44:45], v12 offset:12288
    ds_read_b64_tr_b16 v[46:47], v12 offset:12800
    ds_read_b64_tr_b16 v[72:73], v11 offset:28672
    ds_read_b64_tr_b16 v[74:75], v11 offset:29184
    ds_read_b64_tr_b16 v[76:77], v12 offset:28672
    ds_read_b64_tr_b16 v[78:79], v12 offset:29184
KF_G_PRE:
    s_lshl_b32 s85, s46, 12
    s_lshl_b32 s47, s46, 11
    s_lshl_b32 s84, s80, 7
    s_add_u32 s84, s84, s82
KF_G_LOOP:
    s_waitcnt lgkmcnt(0)
    v_mfma_f32_16x16x32_bf16 v[112:115], v[16:19], v[80:83], 0
    v_mfma_f32_16x16x32_bf16 v[116:119], v[20:23], v[80:83], 0
    v_mfma_f32_16x16x32_bf16 v[120:123], v[48:51], v[80:83], 0
    v_mfma_f32_16x16x32_bf16 v[124:127], v[52:55], v[80:83], 0
    v_mfma_f32_16x16x32_bf16 v[112:115], v[24:27], v[84:87], v[112:115]
    v_mfma_f32_16x16x32_bf16 v[116:119], v[28:31], v[84:87], v[116:119]
    v_mfma_f32_16x16x32_bf16 v[120:123], v[56:59], v[84:87], v[120:123]
    v_mfma_f32_16x16x32_bf16 v[124:127], v[60:63], v[84:87], v[124:127]
    v_mfma_f32_16x16x32_bf16 v[112:115], v[32:35], v[88:91], v[112:115]
    v_mfma_f32_16x16x32_bf16 v[116:119], v[36:39], v[88:91], v[116:119]
    v_mfma_f32_16x16x32_bf16 v[120:123], v[64:67], v[88:91], v[120:123]
    v_mfma_f32_16x16x32_bf16 v[124:127], v[68:71], v[88:91], v[124:127]
    v_mfma_f32_16x16x32_bf16 v[112:115], v[40:43], v[92:95], v[112:115]
    v_mfma_f32_16x16x32_bf16 v[116:119], v[44:47], v[92:95], v[116:119]
    v_mfma_f32_16x16x32_bf16 v[120:123], v[72:75], v[92:95], v[120:123]
    v_mfma_f32_16x16x32_bf16 v[124:127], v[76:79], v[92:95], v[124:127]
    s_add_u32 s97, s96, s46
    s_cmp_ge_u32 s97, s94
    s_cbranch_scc1 KF_G_NOX
    v_add_u32 v7, s85, v7
    v_add_u32 v9, s85, v9
    v_add_u32 v10, s85, v10
    v_add_u32 v13, s85, v13
    s_cmp_eq_u32 s89, 0
    s_cbranch_scc1 KF_G_NOX
    ds_read_b128 v[80:83], v7
    ds_read_b128 v[84:87], v9
    ds_read_b128 v[88:91], v10
    ds_read_b128 v[92:95], v13
KF_G_NOX:
    s_lshl_b32 s98, s96, 12
    s_add_u32 s98, s98, s84
    s_nop 5
    s_cmp_eq_u32 s95, 1
    s_cbranch_scc1 KF_G_EPI_AU
    v_pk_mul_f32 v[112:113], v[112:113], s[90:91] op_sel_hi:[1,0]
    v_pk_mul_f32 v[114:115], v[114:115], s[90:91] op_sel_hi:[1,0]
    v_cvt_pk_bf16_f32 v112, v112, v113
    v_cvt_pk_bf16_f32 v114, v114, v115
    v_perm_b32 v120, v120, v112, s91
    v_perm_b32 v121, v121, v112, s92
    v_perm_b32 v122, v122, v114, s91
    v_perm_b32 v123, v123, v114, s92
    ds_write_b128 v1, v[120:123]
    v_pk_mul_f32 v[116:117], v[116:117], s[90:91] op_sel_hi:[1,0]
    v_pk_mul_f32 v[118:119], v[118:119], s[90:91] op_sel_hi:[1,0]
    v_cvt_pk_bf16_f32 v116, v116, v117
    v_cvt_pk_bf16_f32 v118, v118, v119
    v_perm_b32 v124, v124, v116, s91
    v_perm_b32 v125, v125, v116, s92
    v_perm_b32 v126, v126, v118, s91
    v_perm_b32 v127, v127, v118, s92
    ds_write_b128 v2, v[124:127]
    ds_read_b128 v[96:99], v14
    ds_read_b128 v[100:103], v14 offset:1024
    s_cmp_eq_u32 s96, 12
    s_cselect_b32 s101, 0, -1
    s_mov_b32 s100, -1
    s_mov_b64 exec, s[100:101]
    s_waitcnt lgkmcnt(0)
    buffer_store_dwordx4 v[96:99], v3, s[32:35], s98 offen sc1
    s_mov_b64 exec, -1
    s_cbranch_scc1 KF_G_DONE
    buffer_store_dwordx4 v[100:103], v3, s[32:35], s98 offen offset:2048 sc1
    s_branch KF_G_NEXT
KF_G_EPI_AU:
    s_cmp_lg_u32 s3, 14
    s_cbranch_scc1 KF_G_NOZ
    s_cmp_ge_u32 s96, 3
    s_cbranch_scc1 KF_G_NOZ
    v_and_b32 v6, 1, v0
    v_lshlrev_b32 v6, 7, v6
    s_mov_b64 exec, 3
    buffer_load_dword v6, v6, s[60:63], 0 offen sc1
    s_mov_b64 exec, -1
KF_G_NOZ:
    s_cmp_eq_u32 s96, 6
    s_cselect_b32 s98, 4, 16
    v_cmp_gt_u32 vcc, s98, v3
    v_pk_mul_f32 v[112:113], v[112:113], s[90:91] op_sel_hi:[1,0]
    v_pk_mul_f32 v[114:115], v[114:115], s[90:91] op_sel_hi:[1,0]
    v_cvt_pk_bf16_f32 v112, v112, v113
    v_cvt_pk_bf16_f32 v113, v114, v115
    v_cvt_pk_bf16_f32 v120, v120, v121
    v_cvt_pk_bf16_f32 v121, v122, v123
    v_pk_mul_f32 v[116:117], v[116:117], s[90:91] op_sel_hi:[1,0]
    v_pk_mul_f32 v[118:119], v[118:119], s[90:91] op_sel_hi:[1,0]
    v_cvt_pk_bf16_f32 v116, v116, v117
    v_cvt_pk_bf16_f32 v117, v118, v119
    v_cvt_pk_bf16_f32 v124, v124, v125
    v_cvt_pk_bf16_f32 v125, v126, v127
    s_mov_b64 exec, vcc
    ds_write_b64 v1, v[112:113]
    ds_write_b64 v1, v[120:121] offset:12800
    ds_write_b64 v2, v[116:117]
    ds_write_b64 v2, v[124:125] offset:12800
    s_mov_b64 exec, -1
    v_add_u32 v1, s47, v1
    v_add_u32 v2, s47, v2
KF_G_NEXT:
    s_cmp_lg_u32 s89, 0
    s_cbranch_scc1 KF_G_NX2
    s_mov_b32 s89, 1
KF_G_XW2:
    s_sleep 2
    ds_read_b32 v6, v4 offset:20
    s_waitcnt lgkmcnt(0)
    v_readfirstlane_b32 s98, v6
    s_cmp_lt_u32 s98, 6
    s_cbranch_scc1 KF_G_XW2
    ds_read_b128 v[80:83], v7
    ds_read_b128 v[84:87], v9
    ds_read_b128 v[88:91], v10
    ds_read_b128 v[92:95], v13
KF_G_NX2:
    s_mov_b32 s96, s97
    s_cmp_lt_u32 s96, s94
    s_nop 1
    s_cbranch_scc1 KF_G_LOOP
KF_G_DONE:
    s_setprio 0
    s_lshl_b32 s88, s3, 12
    s_lshl_b32 s97, s29, 2
    s_add_u32 s88, s88, s97
    v_and_b32 v1, 63, v0
    v_and_b32 v9, 15, v1
    v_lshrrev_b32 v8, 4, v1
    v_lshlrev_b32 v2, 4, v9
    v_lshlrev_b32 v3, 2, v1
    v_mov_b32 v126, 1
    v_lshlrev_b32 v12, 9, v1
    s_mov_b32 s90, 1
    s_mov_b32 s80, 0
    s_mov_b32 s81, 64
    v_mov_b32 v13, 163072
    s_mov_b32 s38, 0
    s_mov_b32 s39, 0
    s_mov_b32 s37, 0
    s_cmp_eq_u32 s95, 0
    s_cselect_b32 s36, 1, 0
    s_bitcmp1_b32 s29, 0
    s_cbranch_scc0 KF_NODUMMY
    s_cmp_lg_u32 s3, 6
    s_cbranch_scc1 KF_NODUMMY
    v_mov_b32 v100, 32639
    v_mov_b32 v101, 32639
    v_mov_b32 v102, 32639
    v_mov_b32 v103, 32639
    s_lshl_b32 s97, s83, 10
    s_add_u32 s97, s97, 3211264
    v_lshlrev_b32 v11, 4, v1
    buffer_store_dwordx4 v[100:103], v11, s[32:35], s97 offen sc1
KF_NODUMMY:
    s_cmp_lg_u32 s3, 15
    s_cbranch_scc1 K2_NOWC
    v_lshl_add_u32 v11, v9, 2, v8
    v_lshlrev_b32 v11, 1, v11
    s_lshl_b32 s97, s28, 7
    buffer_load_ushort v112, v11, s[56:59], s97 offen offset:0
    buffer_load_ushort v113, v11, s[56:59], s97 offen offset:256
    buffer_load_ushort v114, v11, s[56:59], s97 offen offset:512
    buffer_load_ushort v115, v11, s[56:59], s97 offen offset:768
K2_NOWC:
    v_bfe_u32 v11, v1, 2, 2
    v_cmp_eq_u32 s[100:101], v8, v11
    v_and_b32 v10, 3, v1
    v_mov_b32 v11, 0x3f80
    v_cmp_eq_u32 vcc, 0, v10
    s_and_b64 vcc, vcc, s[100:101]
    s_nop 1
    v_cndmask_b32 v16, 0, v11, vcc
    v_cmp_eq_u32 vcc, 1, v10
    s_and_b64 vcc, vcc, s[100:101]
    s_nop 1
    v_cndmask_b32 v17, 0, v11, vcc
    v_cmp_eq_u32 vcc, 2, v10
    s_and_b64 vcc, vcc, s[100:101]
    s_nop 1
    v_cndmask_b32 v18, 0, v11, vcc
    v_cmp_eq_u32 vcc, 3, v10
    s_and_b64 vcc, vcc, s[100:101]
    s_nop 1
    v_cndmask_b32 v19, 0, v11, vcc
    v_lshlrev_b32 v10, 4, v0
    v_mov_b32 v84, 12544
    v_lshl_add_u32 v84, v1, 2, v84
    v_add_u32 v85, 1, v84
    v_add_u32 v86, 2, v84
    v_add_u32 v87, 3, v84
    v_mov_b32 v88, 0
    v_mov_b32 v89, 0
    v_mov_b32 v90, 0
    v_mov_b32 v91, 0
    s_cmp_lg_u32 s3, 14
    s_cbranch_scc1 KF_NOZPN
    s_mov_b32 s84, 0
    v_and_b32 v124, 1, v0
    v_lshlrev_b32 v124, 7, v124
    s_mov_b64 exec, 3
    s_bitcmp1_b32 s2, 7
    s_cbranch_scc0 KF_ZPOLLN
    s_waitcnt vmcnt(0)
    v_cmp_gt_u32 vcc, 8, v6
    s_cbranch_vccz KF_ZPOLL_OKN
KF_ZPOLLN:
    buffer_load_dword v125, v124, s[60:63], 0 offen sc1
    s_add_u32 s84, s84, 1
    s_waitcnt vmcnt(0)
    v_cmp_gt_u32 vcc, 8, v125
    s_cbranch_vccz KF_ZPOLL_OKN
    s_sleep 8
    s_cmp_lt_u32 s84, 32768
    s_cbranch_scc1 KF_ZPOLLN
    v_mov_b32 v124, 163072
    v_mov_b32 v125, 1
    ds_write_b32 v124, v125 offset:8
KF_ZPOLL_OKN:
    s_mov_b64 exec, -1
    s_bitcmp1_b32 s2, 7
    s_cbranch_scc1 KF_NOZPN
    ds_read_b64 v[42:43], v39 offset:38912
    ds_read_b64 v[48:49], v39 offset:39424
    s_lshl_b32 s85, s2, 9
    s_waitcnt lgkmcnt(0)
    v_lshl_or_b32 v42, v42, 12, v48
    v_or_b32 v42, 0x80000000, v42
    v_lshl_or_b32 v43, v43, 12, v49
    v_or_b32 v43, 0x80000000, v43
    buffer_store_dwordx2 v[42:43], v39, s[40:43], s85 offen sc1
KF_NOZPN:
    s_lshl_b32 s99, s28, 6
    s_add_u32 s99, s99, s83
    s_lshl_b32 s99, s99, 7
    s_add_u32 s99, s99, 4898816
    v_lshlrev_b32 v11, 14, v1
    s_cmp_eq_u32 s36, 0
    s_cbranch_scc1 KF_NODR
    s_waitcnt vmcnt(0)
KF_NODR:
    s_cmp_eq_u32 s3, 0
    s_cselect_b32 s36, s36, 0
    s_waitcnt lgkmcnt(0)
    s_barrier
    s_cmp_eq_u32 s36, 0
    s_cbranch_scc1 KF_NOFL
    s_mov_b32 s36, 0
    s_mov_b64 exec, 15
    buffer_store_dword v126, v11, s[40:43], s99 offen sc1
    s_mov_b64 exec, -1
KF_NOFL:
    s_mov_b64 exec, 0xff
    buffer_load_dword v124, v12, s[40:43], s88 offen sc1
    s_mov_b64 exec, -1
    ds_read_b32 v122, v13 offset:8
    v_and_b32 v11, 7, v1
    v_mul_u32_u24 v15, 37632, v11
    s_waitcnt vmcnt(0)
    s_cmp_eq_u32 s36, 0
    s_cbranch_scc1 K2_NOTA
    s_mov_b64 exec, 1
    ds_add_rtn_u32 v14, v13, v126 offset:4
K2_NOTA:
    s_mov_b64 exec, 0xff
    v_cmp_le_i32 vcc, 0, v124
    s_mov_b64 exec, -1
    s_cbranch_vccz K2_FAST
    s_waitcnt lgkmcnt(0)
    s_mov_b32 s38, 1
    s_cmp_eq_u32 s36, 0
    s_cbranch_scc1 K2_NOSIGA
    s_mov_b32 s36, 0
    v_readfirstlane_b32 s98, v14
    s_lshl_b32 s99, s28, 6
    s_add_u32 s99, s99, s83
    s_lshl_b32 s99, s99, 7
    s_add_u32 s99, s99, 4898816
    s_cmp_lg_u32 s98, 9
    s_cbranch_scc1 K2_NOSIGA
    v_lshlrev_b32 v11, 14, v1
    s_mov_b64 exec, 15
    buffer_store_dword v126, v11, s[40:43], s99 offen sc1
    s_mov_b64 exec, -1
K2_NOSIGA:
    s_cmp_eq_u32 s3, 14
    s_cbranch_scc1 K2_POSTXA
    s_min_u32 s97, s3, 14
    s_lshl_b32 s97, s97, 10
    v_lshl_add_u32 v10, v1, 4, s97
    ds_write_b128 v10, v[84:87] offset:5888
    v_add_u32 v11, 33536, v10
    ds_write_b128 v11, v[88:91] offset:0
    ds_write_b128 v11, v[88:91] offset:15360
    ds_write_b128 v11, v[88:91] offset:30720
    s_cmp_ge_u32 s97, 12288
    s_cbranch_scc1 KF_NOZ6A
    ds_write_b128 v10, v[84:87] offset:21248
    s_cmp_ge_u32 s97, 7168
    s_cbranch_scc1 KF_NOZ6A
    ds_write_b128 v11, v[88:91] offset:46080
KF_NOZ6A:
    s_cmp_lg_u32 s3, 15
    s_cbranch_scc1 K2_POSTXA
    s_mov_b32 s98, 0xbfb8aa3b
    v_lshlrev_b32 v112, 16, v112
    v_mul_f32 v112, s98, v112
    v_lshlrev_b32 v113, 16, v113
    v_mul_f32 v113, s98, v113
    v_lshlrev_b32 v114, 16, v114
    v_mul_f32 v114, s98, v114
    v_lshlrev_b32 v115, 16, v115
    v_mul_f32 v115, s98, v115
    v_cvt_pk_bf16_f32 v112, v112, v113
    v_cvt_pk_bf16_f32 v113, v114, v115
    v_lshlrev_b32 v10, 3, v1
    ds_write_b64 v10, v[112:113] offset:4672
K2_POSTXA:
    s_cmp_eq_u32 s3, 14
    s_cbranch_scc1 KF_GATE
    s_mov_b32 s99, 0
KF_GWAIT:
    ds_read_b32 v10, v13 offset:24
    s_waitcnt lgkmcnt(0)
    v_readfirstlane_b32 s98, v10
    s_cmp_lg_u32 s98, 0
    s_cbranch_scc1 K2_R1
    s_sleep 1
    s_branch KF_GWAIT
KF_GATE:
    s_mov_b32 s99, 0
    s_mov_b64 exec, 0xff
KF_GPOLL:
    s_sleep 4
    buffer_load_dword v124, v12, s[40:43], s88 offen sc1
    s_add_u32 s99, s99, 1
    s_waitcnt vmcnt(0)
    v_cmp_le_i32 vcc, 0, v124
    s_cbranch_vccz KF_GPOLL_OK
    s_mov_b64 exec, vcc
    s_cmp_lt_u32 s99, 4096
    s_cbranch_scc1 KF_GPOLL
    s_mov_b64 exec, -1
    ds_write_b32 v13, v126 offset:24
    s_branch K2_R1
KF_GPOLL_OK:
    s_mov_b64 exec, -1
K2_FAST:
    s_cmp_lg_u32 s3, 14
    s_cbranch_scc1 K2_POLL_OK
    ds_write_b32 v13, v126 offset:24
    s_branch K2_POLL_OK
K2_ROUND:
    v_mov_b32 v122, 0
    v_lshlrev_b32 v10, 4, v0
    v_mov_b32 v84, 12544
    v_lshl_add_u32 v84, v1, 2, v84
    v_add_u32 v85, 1, v84
    v_add_u32 v86, 2, v84
    v_add_u32 v87, 3, v84
    v_cmp_gt_u32 vcc, 960, v0
    s_mov_b64 exec, vcc
    ds_write_b128 v10, v[84:87] offset:5888
    s_mov_b64 exec, -1
    s_cmp_gt_u32 s3, 4
    s_cbranch_scc1 K2_Z_SKIP
    v_lshlrev_b32 v11, 2, v0
    ds_write_b32 v11, v122 offset:0
K2_Z_SKIP:
    s_waitcnt lgkmcnt(0)
    s_barrier
K2_R1:
    s_mov_b32 s99, 0
    s_mov_b64 exec, 0xff
K2_POLL:
    buffer_load_dword v124, v12, s[40:43], s88 offen sc1
    s_add_u32 s99, s99, 1
    s_waitcnt vmcnt(0)
    v_cmp_le_i32 vcc, 0, v124
    s_cbranch_vccz K2_POLL_OK
    s_mov_b64 exec, vcc
    s_sleep 1
    s_cmp_lt_u32 s99, 262144
    s_cbranch_scc1 K2_POLL
    v_cndmask_b32 v124, v124, 0, vcc
K2_POLL_OK:
    s_mov_b64 exec, -1
    v_and_b32 v116, 0xfff, v124
    v_bfe_u32 v123, v124, 12, 12
    v_mad_u32_u24 v116, v116, 12, v15
    s_add_u32 s98, s80, s81
    v_min_u32 v118, s98, v123
    v_subrev_u32 v118, s80, v118
    v_max_i32 v118, 0, v118
    v_lshl_or_b32 v116, v116, 7, v118
    v_lshrrev_b32 v10, 5, v1
    v_lshlrev_b32 v10, 2, v10
    ds_bpermute_b32 v100, v10, v116 offset:0
    ds_bpermute_b32 v101, v10, v116 offset:8
    ds_bpermute_b32 v102, v10, v116 offset:16
    ds_bpermute_b32 v103, v10, v116 offset:24
    s_mul_i32 s97, s3, 301056
    s_mul_i32 s98, s80, 12
    s_add_u32 s97, s97, s98
    s_add_u32 s97, s97, 81920
    v_and_b32 v117, 31, v1
    v_mul_u32_u24 v118, 12, v117
    v_add_u32 v119, 32, v117
    s_waitcnt lgkmcnt(4)
    v_readfirstlane_b32 s98, v122
    s_cmp_lg_u32 s98, 0
    s_cbranch_scc1 KF_END
    s_cmp_eq_u32 s90, 0
    s_cbranch_scc1 K2_NOSIGB
    s_cmp_eq_u32 s36, 0
    s_cbranch_scc1 K2_NOSIGB
    s_mov_b32 s36, 0
    v_readfirstlane_b32 s98, v14
    s_lshl_b32 s99, s28, 6
    s_add_u32 s99, s99, s83
    s_lshl_b32 s99, s99, 7
    s_add_u32 s99, s99, 4898816
    s_cmp_lg_u32 s98, 9
    s_cbranch_scc1 K2_NOSIGB
    v_lshlrev_b32 v11, 14, v1
    s_mov_b64 exec, 15
    buffer_store_dword v126, v11, s[40:43], s99 offen sc1
    s_mov_b64 exec, -1
K2_NOSIGB:
    s_waitcnt lgkmcnt(3)
    v_and_b32 v120, 0x7f, v100
    v_lshrrev_b32 v100, 7, v100
    v_cmp_lt_u32 s[64:65], v117, v120
    v_cmp_lt_u32 s[72:73], v119, v120
    v_add_u32 v100, v100, v118
    s_mov_b64 exec, s[64:65]
    buffer_load_dwordx3 v[52:54], v100, s[40:43], s97 offen sc1
    s_mov_b64 exec, -1
    s_waitcnt lgkmcnt(2)
    v_and_b32 v120, 0x7f, v101
    v_lshrrev_b32 v101, 7, v101
    v_cmp_lt_u32 s[66:67], v117, v120
    v_cmp_lt_u32 s[74:75], v119, v120
    v_add_u32 v101, v101, v118
    s_mov_b64 exec, s[66:67]
    buffer_load_dwordx3 v[56:58], v101, s[40:43], s97 offen sc1
    s_mov_b64 exec, -1
    s_waitcnt lgkmcnt(1)
    v_and_b32 v120, 0x7f, v102
    v_lshrrev_b32 v102, 7, v102
    v_cmp_lt_u32 s[68:69], v117, v120
    v_cmp_lt_u32 s[76:77], v119, v120
    v_add_u32 v102, v102, v118
    s_mov_b64 exec, s[68:69]
    buffer_load_dwordx3 v[60:62], v102, s[40:43], s97 offen sc1
    s_mov_b64 exec, -1
    s_waitcnt lgkmcnt(0)
    v_and_b32 v120, 0x7f, v103
    v_lshrrev_b32 v103, 7, v103
    v_cmp_lt_u32 s[70:71], v117, v120
    v_cmp_lt_u32 s[78:79], v119, v120
    v_add_u32 v103, v103, v118
    s_mov_b64 exec, s[70:71]
    buffer_load_dwordx3 v[64:66], v103, s[40:43], s97 offen sc1
    s_mov_b64 exec, -1
    s_or_b64 s[98:99], s[72:73], s[74:75]
    s_or_b64 s[100:101], s[76:77], s[78:79]
    s_or_b64 s[98:99], s[98:99], s[100:101]
    s_cselect_b32 s96, 1, 0
    s_cbranch_scc0 K2_SK_LD
    s_mov_b64 exec, s[72:73]
    buffer_load_dwordx3 v[68:70], v100, s[40:43], s97 offen offset:384 sc1
    s_mov_b64 exec, s[74:75]
    buffer_load_dwordx3 v[72:74], v101, s[40:43], s97 offen offset:384 sc1
    s_mov_b64 exec, s[76:77]
    buffer_load_dwordx3 v[76:78], v102, s[40:43], s97 offen offset:384 sc1
    s_mov_b64 exec, s[78:79]
    buffer_load_dwordx3 v[80:82], v103, s[40:43], s97 offen offset:384 sc1
    s_mov_b64 exec, -1
K2_SK_LD:
    s_lshl_b32 s58, s30, 8
    s_lshl_b32 s59, s28, 7
    s_add_u32 s58, s58, s59
    s_lshl_b32 s59, s31, 8
    s_mov_b32 s94, 0x2b800000
    s_mov_b32 s95, 0xc2200000
    s_mov_b32 s56, 0x498637bd
    s_lshl_b32 s93, s28, 13
    s_add_u32 s93, s93, 4898816
    s_bfe_u32 s97, s2, 0x20001
    s_lshl_b32 s97, s97, 14
    s_add_u32 s93, s93, s97
    v_lshlrev_b32 v125, 7, v1
    v_mov_b32 v124, 4
    s_movk_i32 s57, 68
    s_movk_i32 s89, 132
    v_lshlrev_b32 v127, 3, v9
    v_bfe_u32 v5, v1, 2, 2
    v_lshlrev_b32 v5, 5, v5
    v_add_u32 v5, 21248, v5
    v_lshl_add_u32 v4, v8, 4, 0
    v_add_u32 v4, 5888, v4
    s_cmp_eq_u32 s90, 0
    s_cbranch_scc1 K2_W0
    s_mov_b64 exec, 0xff
    ds_max_u32 v13, v123 offset:12
    s_mov_b64 exec, -1
    s_cmp_lg_u32 s38, 0
    s_cbranch_scc1 K2_W0
    s_mov_b32 s38, 1
    s_cmp_eq_u32 s3, 14
    s_cbranch_scc1 K2_POSTXB
    s_min_u32 s97, s3, 14
    s_lshl_b32 s97, s97, 10
    v_lshl_add_u32 v10, v1, 4, s97
    ds_write_b128 v10, v[84:87] offset:5888
    v_add_u32 v11, 33536, v10
    ds_write_b128 v11, v[88:91] offset:0
    ds_write_b128 v11, v[88:91] offset:15360
    ds_write_b128 v11, v[88:91] offset:30720
    s_cmp_ge_u32 s97, 12288
    s_cbranch_scc1 KF_NOZ6B
    ds_write_b128 v10, v[84:87] offset:21248
    s_cmp_ge_u32 s97, 7168
    s_cbranch_scc1 KF_NOZ6B
    ds_write_b128 v11, v[88:91] offset:46080
KF_NOZ6B:
    s_cmp_lg_u32 s3, 15
    s_cbranch_scc1 K2_POSTXB
    s_mov_b32 s98, 0xbfb8aa3b
    v_lshlrev_b32 v112, 16, v112
    v_mul_f32 v112, s98, v112
    v_lshlrev_b32 v113, 16, v113
    v_mul_f32 v113, s98, v113
    v_lshlrev_b32 v114, 16, v114
    v_mul_f32 v114, s98, v114
    v_lshlrev_b32 v115, 16, v115
    v_mul_f32 v115, s98, v115
    v_cvt_pk_bf16_f32 v112, v112, v113
    v_cvt_pk_bf16_f32 v113, v114, v115
    v_lshlrev_b32 v10, 3, v1
    ds_write_b64 v10, v[112:113] offset:4672
K2_POSTXB:
    s_cmp_eq_u32 s37, 0
    s_cbranch_scc1 K2_W0
    s_waitcnt vmcnt(1)
    s_branch K2_W1
K2_W0:
    s_waitcnt vmcnt(0)
K2_W1:
    s_cmp_lg_u32 s3, 14
    s_cbranch_scc1 K2_NOTPA
    buffer_load_dword v118, v125, s[40:43], s93 offen sc1
K2_NOTPA:
    v_lshlrev_b32_sdwa v84, 2, v54 dst_sel:DWORD dst_unused:UNUSED_PAD src0_sel:DWORD src1_sel:WORD_1
    v_lshlrev_b32_sdwa v85, 2, v58 dst_sel:DWORD dst_unused:UNUSED_PAD src0_sel:DWORD src1_sel:WORD_1
    v_lshlrev_b32_sdwa v86, 2, v62 dst_sel:DWORD dst_unused:UNUSED_PAD src0_sel:DWORD src1_sel:WORD_1
    v_lshlrev_b32_sdwa v87, 2, v66 dst_sel:DWORD dst_unused:UNUSED_PAD src0_sel:DWORD src1_sel:WORD_1
    s_mov_b64 exec, s[64:65]
    ds_add_rtn_u32 v55, v84, v124 offset:0
    s_mov_b64 exec, s[66:67]
    ds_add_rtn_u32 v59, v85, v124 offset:0
    s_mov_b64 exec, s[68:69]
    ds_add_rtn_u32 v63, v86, v124 offset:0
    s_mov_b64 exec, s[70:71]
    ds_add_rtn_u32 v67, v87, v124 offset:0
    s_mov_b64 exec, -1
    s_cmp_eq_u32 s96, 0
    s_cbranch_scc1 K2_SK_PA
    v_lshlrev_b32_sdwa v88, 2, v70 dst_sel:DWORD dst_unused:UNUSED_PAD src0_sel:DWORD src1_sel:WORD_1
    v_lshlrev_b32_sdwa v89, 2, v74 dst_sel:DWORD dst_unused:UNUSED_PAD src0_sel:DWORD src1_sel:WORD_1
    v_lshlrev_b32_sdwa v90, 2, v78 dst_sel:DWORD dst_unused:UNUSED_PAD src0_sel:DWORD src1_sel:WORD_1
    v_lshlrev_b32_sdwa v91, 2, v82 dst_sel:DWORD dst_unused:UNUSED_PAD src0_sel:DWORD src1_sel:WORD_1
    s_mov_b64 exec, s[72:73]
    ds_add_rtn_u32 v71, v88, v124 offset:0
    s_mov_b64 exec, s[74:75]
    ds_add_rtn_u32 v75, v89, v124 offset:0
    s_mov_b64 exec, s[76:77]
    ds_add_rtn_u32 v79, v90, v124 offset:0
    s_mov_b64 exec, s[78:79]
    ds_add_rtn_u32 v83, v91, v124 offset:0
    s_mov_b64 exec, -1
K2_SK_PA:
    s_cmp_lg_u32 s3, 15
    s_cbranch_scc1 K2_B10
    s_setprio 3
    s_cmp_eq_u32 s90, 0
    s_cbranch_scc1 K2_B10
    s_waitcnt lgkmcnt(0)
    v_min_u32 v55, 252, v55
    v_mad_u32_u24 v28, v84, s57, v55
    v_min_u32 v59, 252, v59
    v_mad_u32_u24 v29, v85, s57, v59
    v_min_u32 v63, 252, v63
    v_mad_u32_u24 v30, v86, s57, v63
    v_min_u32 v67, 252, v67
    v_mad_u32_u24 v31, v87, s57, v67
    v_min_u32 v71, 252, v71
    v_mad_u32_u24 v32, v88, s57, v71
    v_min_u32 v75, 252, v75
    v_mad_u32_u24 v33, v89, s57, v75
    v_min_u32 v79, 252, v79
    v_mad_u32_u24 v34, v90, s57, v79
    v_min_u32 v83, 252, v83
    v_mad_u32_u24 v35, v91, s57, v83
K2_B10:
    s_waitcnt lgkmcnt(0)
    s_barrier
    s_cmp_lg_u32 s3, 15
    s_cbranch_scc1 K2_S_SKIP
    v_lshlrev_b32 v10, 3, v1
    ds_read_b64 v[100:101], v10 offset:0
    v_cmp_gt_u32 s[100:101], 50, v1
    v_lshlrev_b32 v92, 9, v1
    v_add_u32 v94, 256, v92
    v_and_b32 v93, 7, v1
    v_lshlrev_b32 v93, 4, v93
    v_lshl_add_u32 v93, v1, 8, v93
    v_add_u32 v93, 137472, v93
    v_add_u32 v95, 136, v93
    v_lshlrev_b32 v96, 1, v1
    v_add_u32 v97, 1, v96
    s_cmp_eq_u32 s90, 0
    s_cbranch_scc1 K2_SD0
    s_mov_b64 exec, s[64:65]
    ds_write_b16 v28, v54 offset:5888
    s_mov_b64 exec, s[66:67]
    ds_write_b16 v29, v58 offset:5888
    s_mov_b64 exec, s[68:69]
    ds_write_b16 v30, v62 offset:5888
    s_mov_b64 exec, s[70:71]
    ds_write_b16 v31, v66 offset:5888
    s_mov_b64 exec, s[72:73]
    ds_write_b16 v32, v70 offset:5888
    s_mov_b64 exec, s[74:75]
    ds_write_b16 v33, v74 offset:5888
    s_mov_b64 exec, s[76:77]
    ds_write_b16 v34, v78 offset:5888
    s_mov_b64 exec, s[78:79]
    ds_write_b16 v35, v82 offset:5888
    s_mov_b64 exec, -1
    s_waitcnt lgkmcnt(8)
    s_branch K2_SD0B
K2_SD0:
    s_waitcnt lgkmcnt(0)
K2_SD0B:
    v_add_u32 v104, 12, v100
    v_lshrrev_b32 v104, 4, v104
    v_min_u32 v98, 63, v104
    v_lshlrev_b32 v108, 2, v98
    v_add_u32 v105, 12, v101
    v_lshrrev_b32 v105, 4, v105
    v_min_u32 v99, 63, v105
    v_lshlrev_b32 v109, 2, v99
    s_mov_b64 exec, s[100:101]
    ds_add_rtn_u32 v112, v108, v126 offset:1024
    ds_add_rtn_u32 v113, v109, v126 offset:1024
    s_mov_b64 exec, -1
    ds_read_b32 v116, v3 offset:1024
    s_cmp_lg_u32 s90, 0
    s_cbranch_scc1 K2_SD1W
    v_and_b32 v28, -16, v55
    v_mad_u32_u24 v55, v28, 3, v55
    v_and_b32 v28, -16, v59
    v_mad_u32_u24 v59, v28, 3, v59
    v_and_b32 v28, -16, v63
    v_mad_u32_u24 v63, v28, 3, v63
    v_and_b32 v28, -16, v67
    v_mad_u32_u24 v67, v28, 3, v67
    v_and_b32 v28, -16, v71
    v_mad_u32_u24 v71, v28, 3, v71
    v_and_b32 v28, -16, v75
    v_mad_u32_u24 v75, v28, 3, v75
    v_and_b32 v28, -16, v79
    v_mad_u32_u24 v79, v28, 3, v79
    v_and_b32 v28, -16, v83
    v_mad_u32_u24 v83, v28, 3, v83
K2_SD1W:
    s_waitcnt lgkmcnt(0)
    s_nop 1
    v_add_u32_dpp v116, v116, v116 row_shr:1 row_mask:0xf bank_mask:0xf bound_ctrl:0
    s_nop 1
    v_add_u32_dpp v116, v116, v116 row_shr:2 row_mask:0xf bank_mask:0xf bound_ctrl:0
    s_nop 1
    v_add_u32_dpp v116, v116, v116 row_shr:4 row_mask:0xf bank_mask:0xf bound_ctrl:0
    s_nop 1
    v_add_u32_dpp v116, v116, v116 row_shr:8 row_mask:0xf bank_mask:0xf bound_ctrl:0
    s_nop 1
    v_add_u32_dpp v116, v116, v116 row_bcast:15 row_mask:0xa bank_mask:0xf
    s_nop 1
    v_add_u32_dpp v116, v116, v116 row_bcast:31 row_mask:0xc bank_mask:0xf
    v_sub_u32 v116, 100, v116
    ds_bpermute_b32 v120, v108, v116
    ds_bpermute_b32 v121, v109, v116
    s_waitcnt lgkmcnt(0)
    s_mov_b64 exec, s[100:101]
    s_cmp_eq_u32 s90, 0
    s_cbranch_scc1 K2_SD2
    v_add_u32 v120, v120, v112
    ds_write_b8 v120, v96 offset:1280
    ds_write_b8 v120, v98 offset:1408
    v_add_u32 v121, v121, v113
    ds_write_b8 v121, v97 offset:1280
    ds_write_b8 v121, v99 offset:1408
    s_mov_b64 exec, -1
    s_branch K2_PRB
K2_SD2:
    v_add_u32 v120, v120, v112
    v_lshlrev_b32 v108, 2, v120
    ds_write_b32 v108, v104 offset:3328
    v_add_u32 v121, v121, v113
    v_lshlrev_b32 v109, 2, v121
    ds_write_b32 v109, v105 offset:3328
    v_lshlrev_b32 v110, 3, v120
    ds_write_b64 v110, v[92:93] offset:2304
    v_lshlrev_b32 v111, 3, v121
    ds_write_b64 v111, v[94:95] offset:2304
    s_mov_b64 exec, -1
    v_lshlrev_b32 v117, 4, v1
    v_min_u32 v117, 384, v117
    ds_read_b128 v[100:103], v117 offset:3328
    v_cmp_gt_u32 vcc, 25, v1
    v_and_b32 v108, 0xfc, v120
    v_and_b32 v120, 3, v120
    v_lshlrev_b32 v120, 4, v120
    v_and_b32 v109, 0xfc, v121
    v_and_b32 v121, 3, v121
    v_lshlrev_b32 v121, 4, v121
    s_waitcnt lgkmcnt(0)
    v_max3_u32 v116, v100, v101, v102
    v_max_u32 v116, v116, v103
    v_cndmask_b32 v116, 0, v116, vcc
    v_mov_b32 v117, v116
    s_nop 1
    v_add_u32_dpp v117, v117, v117 row_shr:1 row_mask:0xf bank_mask:0xf bound_ctrl:0
    s_nop 1
    v_add_u32_dpp v117, v117, v117 row_shr:2 row_mask:0xf bank_mask:0xf bound_ctrl:0
    s_nop 1
    v_add_u32_dpp v117, v117, v117 row_shr:4 row_mask:0xf bank_mask:0xf bound_ctrl:0
    s_nop 1
    v_add_u32_dpp v117, v117, v117 row_shr:8 row_mask:0xf bank_mask:0xf bound_ctrl:0
    s_nop 1
    v_add_u32_dpp v117, v117, v117 row_bcast:15 row_mask:0xa bank_mask:0xf
    s_nop 1
    v_add_u32_dpp v117, v117, v117 row_bcast:31 row_mask:0xc bank_mask:0xf
    v_sub_u32 v116, v117, v116
    v_cndmask_b32 v117, -1, v117, vcc
    ds_write_b32 v3, v117 offset:4352
    ds_bpermute_b32 v104, v108, v116
    ds_bpermute_b32 v105, v109, v116
    s_waitcnt lgkmcnt(0)
    v_lshl_add_u32 v100, v104, 6, v120
    v_lshl_add_u32 v101, v105, 6, v121
    s_mov_b64 exec, s[100:101]
    ds_write_b64 v10, v[100:101] offset:1280
    s_mov_b64 exec, -1
    s_branch K2_PRB
K2_S_SKIP:
    s_cmp_lg_u32 s3, 14
    s_cbranch_scc1 K2_NOTP0
    buffer_load_dword v119, v125, s[40:43], s93 offen sc1
K2_NOTP0:
    s_cmp_eq_u32 s90, 0
    s_cbranch_scc1 K2_NOE2
    v_min_u32 v55, 252, v55
    v_mad_u32_u24 v28, v84, s57, v55
    v_min_u32 v59, 252, v59
    v_mad_u32_u24 v29, v85, s57, v59
    v_min_u32 v63, 252, v63
    v_mad_u32_u24 v30, v86, s57, v63
    v_min_u32 v67, 252, v67
    v_mad_u32_u24 v31, v87, s57, v67
    s_mov_b64 exec, s[64:65]
    ds_write_b16 v28, v54 offset:5888
    s_mov_b64 exec, s[66:67]
    ds_write_b16 v29, v58 offset:5888
    s_mov_b64 exec, s[68:69]
    ds_write_b16 v30, v62 offset:5888
    s_mov_b64 exec, s[70:71]
    ds_write_b16 v31, v66 offset:5888
    s_mov_b64 exec, -1
    s_cmp_eq_u32 s96, 0
    s_cbranch_scc1 K2_TP
    v_min_u32 v71, 252, v71
    v_mad_u32_u24 v32, v88, s57, v71
    v_min_u32 v75, 252, v75
    v_mad_u32_u24 v33, v89, s57, v75
    v_min_u32 v79, 252, v79
    v_mad_u32_u24 v34, v90, s57, v79
    v_min_u32 v83, 252, v83
    v_mad_u32_u24 v35, v91, s57, v83
    s_mov_b64 exec, s[72:73]
    ds_write_b16 v32, v70 offset:5888
    s_mov_b64 exec, s[74:75]
    ds_write_b16 v33, v74 offset:5888
    s_mov_b64 exec, s[76:77]
    ds_write_b16 v34, v78 offset:5888
    s_mov_b64 exec, s[78:79]
    ds_write_b16 v35, v82 offset:5888
    s_mov_b64 exec, -1
    s_branch K2_TP
K2_NOE2:
    v_and_b32 v100, -16, v55
    v_mad_u32_u24 v55, v100, 3, v55
    v_and_b32 v100, -16, v59
    v_mad_u32_u24 v59, v100, 3, v59
    v_and_b32 v100, -16, v63
    v_mad_u32_u24 v63, v100, 3, v63
    v_and_b32 v100, -16, v67
    v_mad_u32_u24 v67, v100, 3, v67
    v_and_b32 v100, -16, v71
    v_mad_u32_u24 v71, v100, 3, v71
    v_and_b32 v100, -16, v75
    v_mad_u32_u24 v75, v100, 3, v75
    v_and_b32 v100, -16, v79
    v_mad_u32_u24 v79, v100, 3, v79
    v_and_b32 v100, -16, v83
    v_mad_u32_u24 v83, v100, 3, v83
K2_TP:
    s_cmp_lg_u32 s3, 14
    s_cbranch_scc1 K2_PRB
    s_waitcnt vmcnt(1)
    v_cmp_ne_u32 vcc, 1, v118
    s_cbranch_vccz K2_POLLT_OK
    s_mov_b32 s100, 0
    s_branch K2_POLLT1
K2_POLLT:
    buffer_load_dword v119, v125, s[40:43], s93 offen sc1
K2_POLLT1:
    s_add_u32 s100, s100, 1
    s_waitcnt vmcnt(0)
    v_cmp_ne_u32 vcc, 1, v119
    s_cbranch_vccz K2_POLLT_OK
    s_mov_b64 exec, vcc
    s_sleep 2
    s_cmp_lt_u32 s100, 262144
    s_cbranch_scc1 K2_POLLT
K2_POLLT_OK:
    s_mov_b64 exec, -1
K2_PRB:
    v_lshlrev_b32 v10, 3, v1
    ds_read_b64 v[94:95], v10 offset:4672
    ds_read_b32 v11, v13 offset:12
    v_mov_b32 v10, 0
    s_waitcnt lgkmcnt(0)
    v_readfirstlane_b32 s82, v11
    s_barrier
    s_setprio 0
    s_cmp_eq_u32 s90, 0
    s_cbranch_scc1 K2_GENERIC
    ds_read_u8 v7, v3 offset:1408
    ds_read_b32 v12, v3 offset:1280
    ds_read_b32 v10, v10 offset:1024
    v_cmp_gt_u32 vcc, 25, v1
    v_bfe_u32 v15, v1, 2, 2
    v_lshlrev_b32 v15, 3, v15
    v_lshlrev_b32 v13, 3, v8
    s_sub_u32 s100, 100, s31
    s_mov_b32 s90, 0
    s_waitcnt lgkmcnt(2)
    v_add_u32_dpp v7, v7, v7 row_shr:1 row_mask:0xf bank_mask:0xf
    s_nop 1
    v_add_u32_dpp v7, v7, v7 row_shr:2 row_mask:0xf bank_mask:0xf
    s_nop 1
    v_add_u32_dpp v7, v7, v7 row_shr:4 row_mask:0xf bank_mask:0xf
    s_nop 1
    v_add_u32_dpp v7, v7, v7 row_shr:8 row_mask:0xf bank_mask:0xf
    s_nop 1
    v_add_u32_dpp v7, v7, v7 row_bcast:15 row_mask:0xa bank_mask:0xf
    s_waitcnt lgkmcnt(0)
    v_readfirstlane_b32 s36, v10
    v_cndmask_b32 v7, -1, v7, vcc
    s_nop 0
    v_readlane_b32 s83, v7, 24
    v_readfirstlane_b32 s101, v7
    s_lshr_b32 s97, s83, 4
    s_and_b32 s98, s83, 15
    s_mul_i32 s84, s97, s3
    s_min_u32 s85, s3, s98
    s_add_u32 s84, s84, s85
    s_cmp_lt_u32 s3, s98
    s_addc_u32 s85, s84, s97
    v_cmp_ge_u32 vcc, s84, v7
    s_bcnt1_i32_b64 s86, vcc
    s_cmp_lg_u32 s36, s100
    s_cbranch_scc1 K2_REDO2
    s_cmp_lt_u32 s81, s82
    s_cbranch_scc1 K2_REDO2
    s_cmp_gt_u32 s101, 16
    s_cbranch_scc1 K2_REDO2
    s_cmp_lt_u32 s83, 16
    s_cbranch_scc1 K2_REDO2
    s_sub_u32 s36, s86, 1
    s_max_i32 s36, s36, 0
    v_readlane_b32 s39, v12, s86
    v_readlane_b32 s92, v7, s36
    v_readlane_b32 s81, v7, s86
    s_cmp_eq_u32 s86, 0
    s_cselect_b32 s92, 0, s92
    v_bfe_u32 v4, s39, v13, 8
    s_sub_u32 s100, s84, s92
    s_lshl_b32 s101, s100, 4
    v_mul_u32_u24 v4, 272, v4
    s_add_u32 s101, s101, 32
    v_add_u32 v4, s101, v4
    ds_read_b128 v[100:103], v4 offset:5856
    s_sub_u32 s81, s81, 3
    s_mov_b32 s80, s86
    s_mov_b32 s38, s96
    s_movk_i32 s93, 272
    s_movk_i32 s88, 528
    s_mov_b32 s90, 137472
    s_lshl_b32 s100, s101, 1
    s_sub_u32 s82, s84, 2
    s_cmp_lg_u32 s82, s81
    s_cbranch_scc1 K2_PS1
    s_add_u32 s80, s80, 1
    s_nop 0
    v_readlane_b32 s36, v12, s80
    v_readlane_b32 s81, v7, s80
    s_nop 0
    v_bfe_u32 v4, s36, v13, 8
    s_sub_u32 s81, s81, 3
    v_mad_u32_u24 v4, v4, s93, 16
K2_PS1:
    ds_read_b128 v[108:111], v4 offset:5872
    v_bfe_u32 v96, s39, v13, 8
    v_xor_b32 v98, v96, v9
    v_and_b32 v98, 15, v98
    v_lshl_add_u32 v98, v98, 3, s90
    v_lshl_add_u32 v98, v96, 7, v98
    v_lshl_add_u32 v99, v96, 8, v127
    ds_read_b64 v[92:93], v98
    v_bfe_u32 v5, s39, v15, 8
    v_mul_u32_u24 v5, 528, v5
    v_add_u32 v5, s100, v5
    s_add_u32 s82, s82, 1
    s_waitcnt lgkmcnt(2)
    v_lshl_add_u32 v100, v100, 8, v2
    v_lshl_add_u32 v101, v101, 8, v2
    v_lshl_add_u32 v102, v102, 8, v2
    v_lshl_add_u32 v103, v103, 8, v2
    buffer_load_dwordx4 v[20:23], v100, s[32:35], 0 offen sc1
    buffer_load_dwordx4 v[24:27], v101, s[32:35], 0 offen sc1
    buffer_load_dwordx4 v[28:31], v102, s[32:35], 0 offen sc1
    buffer_load_dwordx4 v[32:35], v103, s[32:35], 0 offen sc1
    v_lshlrev_b32 v55, 1, v55
    v_mad_u32_u24 v55, v84, s89, v55
    v_lshlrev_b32 v59, 1, v59
    v_mad_u32_u24 v59, v85, s89, v59
    v_lshlrev_b32 v63, 1, v63
    v_mad_u32_u24 v63, v86, s89, v63
    v_lshlrev_b32 v67, 1, v67
    v_mad_u32_u24 v67, v87, s89, v67
    s_mov_b64 exec, s[64:65]
    ds_write_b64 v55, v[52:53] offset:33536
    s_mov_b64 exec, s[66:67]
    ds_write_b64 v59, v[56:57] offset:33536
    s_mov_b64 exec, s[68:69]
    ds_write_b64 v63, v[60:61] offset:33536
    s_mov_b64 exec, s[70:71]
    ds_write_b64 v67, v[64:65] offset:33536
    s_mov_b64 exec, -1
    s_cmp_eq_u32 s38, 0
    s_cbranch_scc1 K2_NOE3
    v_lshlrev_b32 v71, 1, v71
    v_mad_u32_u24 v71, v88, s89, v71
    v_lshlrev_b32 v75, 1, v75
    v_mad_u32_u24 v75, v89, s89, v75
    v_lshlrev_b32 v79, 1, v79
    v_mad_u32_u24 v79, v90, s89, v79
    v_lshlrev_b32 v83, 1, v83
    v_mad_u32_u24 v83, v91, s89, v83
    s_mov_b64 exec, s[72:73]
    ds_write_b64 v71, v[68:69] offset:33536
    s_mov_b64 exec, s[74:75]
    ds_write_b64 v75, v[72:73] offset:33536
    s_mov_b64 exec, s[76:77]
    ds_write_b64 v79, v[76:77] offset:33536
    s_mov_b64 exec, s[78:79]
    ds_write_b64 v83, v[80:81] offset:33536
    s_mov_b64 exec, -1
K2_NOE3:
    v_cmp_gt_u32 vcc, 16, v1
    v_min_u32 v123, s98, v1
    v_mad_u32_u24 v123, s97, v1, v123
    v_cndmask_b32 v123, -1, v123, vcc
    v_mov_b64 v[84:85], 0
    v_mov_b64 v[86:87], 0
    v_mov_b64 v[88:89], 0
    v_mov_b64 v[90:91], 0
    s_sub_u32 s96, s85, 2
    s_max_i32 s96, s96, 0
    s_sub_u32 s97, s85, 6
    s_sub_u32 s98, s85, 3
    s_sub_u32 s99, s85, 1
    s_waitcnt lgkmcnt(0)
    s_barrier
    s_mov_b64 exec, s[44:45]
    ds_read_b128 v[84:87], v5 offset:33472
    ds_read_b128 v[88:91], v5 offset:33488
    s_mov_b64 exec, -1
    v_and_b32 v107, 0xffff0000, v93
    v_lshlrev_b32 v106, 16, v93
    v_and_b32 v105, 0xffff0000, v92
    v_lshlrev_b32 v104, 16, v92
    v_pk_add_f32 v[104:105], v[104:105], s[94:95] op_sel:[0,1] op_sel_hi:[1,1]
    v_pk_add_f32 v[106:107], v[106:107], s[94:95] op_sel:[0,1] op_sel_hi:[1,1]
    v_lshl_add_u32 v108, v108, 8, v2
    v_lshl_add_u32 v109, v109, 8, v2
    v_lshl_add_u32 v110, v110, 8, v2
    v_lshl_add_u32 v111, v111, 8, v2
    buffer_load_dwordx4 v[36:39], v108, s[32:35], 0 offen sc1
    buffer_load_dwordx4 v[40:43], v109, s[32:35], 0 offen sc1
    buffer_load_dwordx4 v[44:47], v110, s[32:35], 0 offen sc1
    buffer_load_dwordx4 v[48:51], v111, s[32:35], 0 offen sc1
    s_cmp_lg_u32 s82, s81
    s_cbranch_scc1 K2_PS2
    s_add_u32 s80, s80, 1
    s_nop 0
    v_readlane_b32 s36, v12, s80
    v_readlane_b32 s81, v7, s80
    s_nop 0
    v_bfe_u32 v4, s36, v13, 8
    s_sub_u32 s81, s81, 3
    v_mad_u32_u24 v4, v4, s93, 0
K2_PS2:
    ds_read_b128 v[100:103], v4 offset:5888
    v_add_u32 v4, 48, v4
    s_add_u32 s36, s86, 1
    v_readlane_b32 s91, v7, s86
    v_mov_b32 v122, v99
    v_readlane_b32 s39, v12, s36
    ds_read_b64 v[120:121], v98 offset:12800
    buffer_load_dwordx2 v[116:117], v99, s[48:51], s58 offen
    s_mov_b32 s47, s84
    s_min_u32 s87, s91, s85
    s_cmp_lt_u32 s92, s84
    s_cselect_b32 s46, 1, 0
    s_cselect_b32 s100, 0, s56
    s_cmp_gt_u32 s91, s85
    s_cselect_b32 s46, 1, s46
    v_mov_b32 v108, s100
    v_mov_b32 v109, s100
    v_mov_b32 v110, s100
    v_mov_b32 v111, s100
    v_mov_b64 v[112:113], 0
    v_mov_b64 v[114:115], 0
    v_bfe_u32 v96, s39, v13, 8
    v_xor_b32 v98, v96, v9
    v_and_b32 v98, 15, v98
    v_lshl_add_u32 v98, v98, 3, s90
    v_lshl_add_u32 v98, v96, 7, v98
    v_lshl_add_u32 v99, v96, 8, v127
    ds_read_b64 v[92:93], v98
    s_setprio 3
    s_waitcnt vmcnt(5) lgkmcnt(0)
    v_mfma_f32_16x16x16_bf16 v[72:75], v[86:87], v[94:95], v[104:107]
    v_mfma_f32_16x16x16_bf16 v[80:83], v[90:91], v[94:95], v[104:107]
    v_mfma_f32_16x16x32_bf16 v[72:75], v[16:19], v[24:27], v[72:75]
    v_mfma_f32_16x16x32_bf16 v[80:83], v[16:19], v[32:35], v[80:83]
    s_nop 6
.p2align 6
K2_LOOPF:
K2_STEP0F:
    v_mfma_f32_16x16x16_bf16 v[68:71], v[84:85], v[94:95], v[104:107]
    v_exp_f32_e64 v72, v72 clamp
    v_mfma_f32_16x16x16_bf16 v[76:79], v[88:89], v[94:95], v[104:107]
    v_exp_f32_e64 v73, v73 clamp
    v_mfma_f32_16x16x32_bf16 v[68:71], v[16:19], v[20:23], v[68:71]
    v_exp_f32_e64 v74, v74 clamp
    v_mfma_f32_16x16x32_bf16 v[76:79], v[16:19], v[28:31], v[76:79]
    v_exp_f32_e64 v75, v75 clamp
    v_exp_f32_e64 v80, v80 clamp
    v_exp_f32_e64 v81, v81 clamp
    v_exp_f32_e64 v82, v82 clamp
    v_exp_f32_e64 v83, v83 clamp
    s_cmp_lt_u32 s84, s96
    s_cselect_b64 exec, -1, 1
    v_lshl_add_u32 v100, v100, 8, v2
    v_lshl_add_u32 v101, v101, 8, v2
    v_lshl_add_u32 v102, v102, 8, v2
    v_lshl_add_u32 v103, v103, 8, v2
    buffer_load_dwordx4 v[52:55], v100, s[32:35], 0 offen sc1
    buffer_load_dwordx4 v[56:59], v101, s[32:35], 0 offen sc1
    buffer_load_dwordx4 v[60:63], v102, s[32:35], 0 offen sc1
    buffer_load_dwordx4 v[64:67], v103, s[32:35], 0 offen sc1
    s_mov_b64 exec, -1
    s_cmp_eq_u32 s84, s81
    s_cbranch_scc1 K2_PSW0
K2_PSR0:
    ds_read_b128 v[100:103], v4 offset:5856
    s_mov_b64 exec, s[44:45]
    ds_read_b128 v[84:87], v5 offset:33504
    ds_read_b128 v[88:91], v5 offset:33520
    s_mov_b64 exec, -1
    s_add_u32 s84, s84, 1
    v_exp_f32_e64 v68, v68 clamp
    v_exp_f32_e64 v69, v69 clamp
    v_exp_f32_e64 v70, v70 clamp
    v_exp_f32_e64 v71, v71 clamp
    v_exp_f32_e64 v76, v76 clamp
    v_exp_f32_e64 v77, v77 clamp
    v_exp_f32_e64 v78, v78 clamp
    v_exp_f32_e64 v79, v79 clamp
    v_pk_add_f32 v[72:73], v[72:73], s[94:95] op_sel_hi:[1,0]
    v_pk_add_f32 v[74:75], v[74:75], s[94:95] op_sel_hi:[1,0]
    v_pk_add_f32 v[80:81], v[80:81], s[94:95] op_sel_hi:[1,0]
    v_pk_add_f32 v[82:83], v[82:83], s[94:95] op_sel_hi:[1,0]
    v_pk_add_f32 v[68:69], v[68:69], s[94:95] op_sel_hi:[1,0]
    v_pk_add_f32 v[70:71], v[70:71], s[94:95] op_sel_hi:[1,0]
    v_pk_add_f32 v[76:77], v[76:77], s[94:95] op_sel_hi:[1,0]
    v_pk_add_f32 v[78:79], v[78:79], s[94:95] op_sel_hi:[1,0]
    v_pk_mul_f32 v[20:21], v[20:21], v[72:73]
    v_pk_mul_f32 v[22:23], v[22:23], v[74:75]
    v_pk_mul_f32 v[28:29], v[28:29], v[80:81]
    v_pk_mul_f32 v[30:31], v[30:31], v[82:83]
    v_pk_fma_f32 v[20:21], v[24:25], v[68:69], v[20:21]
    v_pk_fma_f32 v[22:23], v[26:27], v[70:71], v[22:23]
    v_pk_fma_f32 v[28:29], v[32:33], v[76:77], v[28:29]
    v_pk_fma_f32 v[30:31], v[34:35], v[78:79], v[30:31]
    v_pk_mul_f32 v[24:25], v[68:69], v[72:73]
    v_pk_mul_f32 v[26:27], v[70:71], v[74:75]
    v_pk_mul_f32 v[32:33], v[76:77], v[80:81]
    v_pk_mul_f32 v[34:35], v[78:79], v[82:83]
    v_pk_add_f32 v[68:69], v[68:69], v[72:73]
    v_pk_add_f32 v[70:71], v[70:71], v[74:75]
    v_pk_add_f32 v[76:77], v[76:77], v[80:81]
    v_pk_add_f32 v[78:79], v[78:79], v[82:83]
    s_cmp_lg_u32 s84, s97
    s_cbranch_scc1 K2_PR00
    s_setprio 2
K2_PR00:
    s_cmp_lg_u32 s84, s98
    s_cbranch_scc1 K2_PR01
    s_setprio 1
K2_PR01:
    s_cmp_lg_u32 s84, s99
    s_cbranch_scc1 K2_PR02
    s_setprio 0
K2_PR02:
    s_cmp_ge_u32 s84, s87
    s_cbranch_scc1 K2_BND0F
    s_waitcnt vmcnt(4) lgkmcnt(0)
    v_mfma_f32_16x16x16_bf16 v[72:75], v[86:87], v[94:95], v[104:107]
    v_rcp_f32 v24, v24
    v_mfma_f32_16x16x16_bf16 v[80:83], v[90:91], v[94:95], v[104:107]
    v_rcp_f32 v25, v25
    v_mfma_f32_16x16x32_bf16 v[72:75], v[16:19], v[40:43], v[72:75]
    v_rcp_f32 v26, v26
    v_mfma_f32_16x16x32_bf16 v[80:83], v[16:19], v[48:51], v[80:83]
    v_rcp_f32 v27, v27
    v_rcp_f32 v32, v32
    v_rcp_f32 v33, v33
    v_rcp_f32 v34, v34
    v_rcp_f32 v35, v35
    v_pk_fma_f32 v[108:109], v[68:69], v[24:25], v[108:109]
    v_pk_fma_f32 v[112:113], v[20:21], v[24:25], v[112:113]
    v_pk_fma_f32 v[110:111], v[70:71], v[26:27], v[110:111]
    v_pk_fma_f32 v[114:115], v[22:23], v[26:27], v[114:115]
    v_pk_fma_f32 v[108:109], v[76:77], v[32:33], v[108:109]
    v_pk_fma_f32 v[112:113], v[28:29], v[32:33], v[112:113]
    v_pk_fma_f32 v[110:111], v[78:79], v[34:35], v[110:111]
    v_pk_fma_f32 v[114:115], v[30:31], v[34:35], v[114:115]
K2_STEP1F:
    v_mfma_f32_16x16x16_bf16 v[68:71], v[84:85], v[94:95], v[104:107]
    v_exp_f32_e64 v72, v72 clamp
    v_mfma_f32_16x16x16_bf16 v[76:79], v[88:89], v[94:95], v[104:107]
    v_exp_f32_e64 v73, v73 clamp
    v_mfma_f32_16x16x32_bf16 v[68:71], v[16:19], v[36:39], v[68:71]
    v_exp_f32_e64 v74, v74 clamp
    v_mfma_f32_16x16x32_bf16 v[76:79], v[16:19], v[44:47], v[76:79]
    v_exp_f32_e64 v75, v75 clamp
    v_exp_f32_e64 v80, v80 clamp
    v_exp_f32_e64 v81, v81 clamp
    v_exp_f32_e64 v82, v82 clamp
    v_exp_f32_e64 v83, v83 clamp
    s_cmp_lt_u32 s84, s96
    s_cselect_b64 exec, -1, 1
    v_lshl_add_u32 v100, v100, 8, v2
    v_lshl_add_u32 v101, v101, 8, v2
    v_lshl_add_u32 v102, v102, 8, v2
    v_lshl_add_u32 v103, v103, 8, v2
    buffer_load_dwordx4 v[20:23], v100, s[32:35], 0 offen sc1
    buffer_load_dwordx4 v[24:27], v101, s[32:35], 0 offen sc1
    buffer_load_dwordx4 v[28:31], v102, s[32:35], 0 offen sc1
    buffer_load_dwordx4 v[32:35], v103, s[32:35], 0 offen sc1
    s_mov_b64 exec, -1
    s_cmp_eq_u32 s84, s81
    s_cbranch_scc1 K2_PSW1
K2_PSR1:
    ds_read_b128 v[100:103], v4 offset:5872
    s_mov_b64 exec, s[44:45]
    ds_read_b128 v[84:87], v5 offset:33536
    ds_read_b128 v[88:91], v5 offset:33552
    s_mov_b64 exec, -1
    s_add_u32 s84, s84, 1
    v_exp_f32_e64 v68, v68 clamp
    v_exp_f32_e64 v69, v69 clamp
    v_exp_f32_e64 v70, v70 clamp
    v_exp_f32_e64 v71, v71 clamp
    v_exp_f32_e64 v76, v76 clamp
    v_exp_f32_e64 v77, v77 clamp
    v_exp_f32_e64 v78, v78 clamp
    v_exp_f32_e64 v79, v79 clamp
    v_pk_add_f32 v[72:73], v[72:73], s[94:95] op_sel_hi:[1,0]
    v_pk_add_f32 v[74:75], v[74:75], s[94:95] op_sel_hi:[1,0]
    v_pk_add_f32 v[80:81], v[80:81], s[94:95] op_sel_hi:[1,0]
    v_pk_add_f32 v[82:83], v[82:83], s[94:95] op_sel_hi:[1,0]
    v_pk_add_f32 v[68:69], v[68:69], s[94:95] op_sel_hi:[1,0]
    v_pk_add_f32 v[70:71], v[70:71], s[94:95] op_sel_hi:[1,0]
    v_pk_add_f32 v[76:77], v[76:77], s[94:95] op_sel_hi:[1,0]
    v_pk_add_f32 v[78:79], v[78:79], s[94:95] op_sel_hi:[1,0]
    v_pk_mul_f32 v[36:37], v[36:37], v[72:73]
    v_pk_mul_f32 v[38:39], v[38:39], v[74:75]
    v_pk_mul_f32 v[44:45], v[44:45], v[80:81]
    v_pk_mul_f32 v[46:47], v[46:47], v[82:83]
    v_pk_fma_f32 v[36:37], v[40:41], v[68:69], v[36:37]
    v_pk_fma_f32 v[38:39], v[42:43], v[70:71], v[38:39]
    v_pk_fma_f32 v[44:45], v[48:49], v[76:77], v[44:45]
    v_pk_fma_f32 v[46:47], v[50:51], v[78:79], v[46:47]
    v_pk_mul_f32 v[40:41], v[68:69], v[72:73]
    v_pk_mul_f32 v[42:43], v[70:71], v[74:75]
    v_pk_mul_f32 v[48:49], v[76:77], v[80:81]
    v_pk_mul_f32 v[50:51], v[78:79], v[82:83]
    v_pk_add_f32 v[68:69], v[68:69], v[72:73]
    v_pk_add_f32 v[70:71], v[70:71], v[74:75]
    v_pk_add_f32 v[76:77], v[76:77], v[80:81]
    v_pk_add_f32 v[78:79], v[78:79], v[82:83]
    s_cmp_lg_u32 s84, s97
    s_cbranch_scc1 K2_PR10
    s_setprio 2
K2_PR10:
    s_cmp_lg_u32 s84, s98
    s_cbranch_scc1 K2_PR11
    s_setprio 1
K2_PR11:
    s_cmp_lg_u32 s84, s99
    s_cbranch_scc1 K2_PR12
    s_setprio 0
K2_PR12:
    s_cmp_ge_u32 s84, s87
    s_cbranch_scc1 K2_BND1F
    s_waitcnt vmcnt(4) lgkmcnt(0)
    v_mfma_f32_16x16x16_bf16 v[72:75], v[86:87], v[94:95], v[104:107]
    v_rcp_f32 v40, v40
    v_mfma_f32_16x16x16_bf16 v[80:83], v[90:91], v[94:95], v[104:107]
    v_rcp_f32 v41, v41
    v_mfma_f32_16x16x32_bf16 v[72:75], v[16:19], v[56:59], v[72:75]
    v_rcp_f32 v42, v42
    v_mfma_f32_16x16x32_bf16 v[80:83], v[16:19], v[64:67], v[80:83]
    v_rcp_f32 v43, v43
    v_rcp_f32 v48, v48
    v_rcp_f32 v49, v49
    v_rcp_f32 v50, v50
    v_rcp_f32 v51, v51
    v_pk_fma_f32 v[108:109], v[68:69], v[40:41], v[108:109]
    v_pk_fma_f32 v[112:113], v[36:37], v[40:41], v[112:113]
    v_pk_fma_f32 v[110:111], v[70:71], v[42:43], v[110:111]
    v_pk_fma_f32 v[114:115], v[38:39], v[42:43], v[114:115]
    v_pk_fma_f32 v[108:109], v[76:77], v[48:49], v[108:109]
    v_pk_fma_f32 v[112:113], v[44:45], v[48:49], v[112:113]
    v_pk_fma_f32 v[110:111], v[78:79], v[50:51], v[110:111]
    v_pk_fma_f32 v[114:115], v[46:47], v[50:51], v[114:115]
K2_STEP2F:
    v_mfma_f32_16x16x16_bf16 v[68:71], v[84:85], v[94:95], v[104:107]
    v_exp_f32_e64 v72, v72 clamp
    v_mfma_f32_16x16x16_bf16 v[76:79], v[88:89], v[94:95], v[104:107]
    v_exp_f32_e64 v73, v73 clamp
    v_mfma_f32_16x16x32_bf16 v[68:71], v[16:19], v[52:55], v[68:71]
    v_exp_f32_e64 v74, v74 clamp
    v_mfma_f32_16x16x32_bf16 v[76:79], v[16:19], v[60:63], v[76:79]
    v_exp_f32_e64 v75, v75 clamp
    v_exp_f32_e64 v80, v80 clamp
    v_exp_f32_e64 v81, v81 clamp
    v_exp_f32_e64 v82, v82 clamp
    v_exp_f32_e64 v83, v83 clamp
    s_cmp_lt_u32 s84, s96
    s_cselect_b64 exec, -1, 1
    v_lshl_add_u32 v100, v100, 8, v2
    v_lshl_add_u32 v101, v101, 8, v2
    v_lshl_add_u32 v102, v102, 8, v2
    v_lshl_add_u32 v103, v103, 8, v2
    buffer_load_dwordx4 v[36:39], v100, s[32:35], 0 offen sc1
    buffer_load_dwordx4 v[40:43], v101, s[32:35], 0 offen sc1
    buffer_load_dwordx4 v[44:47], v102, s[32:35], 0 offen sc1
    buffer_load_dwordx4 v[48:51], v103, s[32:35], 0 offen sc1
    s_mov_b64 exec, -1
    s_cmp_eq_u32 s84, s81
    s_cbranch_scc1 K2_PSW2
K2_PSR2:
    ds_read_b128 v[100:103], v4 offset:5888
    s_mov_b64 exec, s[44:45]
    ds_read_b128 v[84:87], v5 offset:33568
    ds_read_b128 v[88:91], v5 offset:33584
    s_mov_b64 exec, -1
    v_add_u32 v4, 48, v4
    v_add_u32 v5, 96, v5
    s_add_u32 s84, s84, 1
    v_exp_f32_e64 v68, v68 clamp
    v_exp_f32_e64 v69, v69 clamp
    v_exp_f32_e64 v70, v70 clamp
    v_exp_f32_e64 v71, v71 clamp
    v_exp_f32_e64 v76, v76 clamp
    v_exp_f32_e64 v77, v77 clamp
    v_exp_f32_e64 v78, v78 clamp
    v_exp_f32_e64 v79, v79 clamp
    v_pk_add_f32 v[72:73], v[72:73], s[94:95] op_sel_hi:[1,0]
    v_pk_add_f32 v[74:75], v[74:75], s[94:95] op_sel_hi:[1,0]
    v_pk_add_f32 v[80:81], v[80:81], s[94:95] op_sel_hi:[1,0]
    v_pk_add_f32 v[82:83], v[82:83], s[94:95] op_sel_hi:[1,0]
    v_pk_add_f32 v[68:69], v[68:69], s[94:95] op_sel_hi:[1,0]
    v_pk_add_f32 v[70:71], v[70:71], s[94:95] op_sel_hi:[1,0]
    v_pk_add_f32 v[76:77], v[76:77], s[94:95] op_sel_hi:[1,0]
    v_pk_add_f32 v[78:79], v[78:79], s[94:95] op_sel_hi:[1,0]
    v_pk_mul_f32 v[52:53], v[52:53], v[72:73]
    v_pk_mul_f32 v[54:55], v[54:55], v[74:75]
    v_pk_mul_f32 v[60:61], v[60:61], v[80:81]
    v_pk_mul_f32 v[62:63], v[62:63], v[82:83]
    v_pk_fma_f32 v[52:53], v[56:57], v[68:69], v[52:53]
    v_pk_fma_f32 v[54:55], v[58:59], v[70:71], v[54:55]
    v_pk_fma_f32 v[60:61], v[64:65], v[76:77], v[60:61]
    v_pk_fma_f32 v[62:63], v[66:67], v[78:79], v[62:63]
    v_pk_mul_f32 v[56:57], v[68:69], v[72:73]
    v_pk_mul_f32 v[58:59], v[70:71], v[74:75]
    v_pk_mul_f32 v[64:65], v[76:77], v[80:81]
    v_pk_mul_f32 v[66:67], v[78:79], v[82:83]
    v_pk_add_f32 v[68:69], v[68:69], v[72:73]
    v_pk_add_f32 v[70:71], v[70:71], v[74:75]
    v_pk_add_f32 v[76:77], v[76:77], v[80:81]
    v_pk_add_f32 v[78:79], v[78:79], v[82:83]
    s_cmp_lg_u32 s84, s97
    s_cbranch_scc1 K2_PR20
    s_setprio 2
K2_PR20:
    s_cmp_lg_u32 s84, s98
    s_cbranch_scc1 K2_PR21
    s_setprio 1
K2_PR21:
    s_cmp_lg_u32 s84, s99
    s_cbranch_scc1 K2_PR22
    s_setprio 0
K2_PR22:
    s_cmp_ge_u32 s84, s87
    s_cbranch_scc1 K2_BND2F
    s_waitcnt vmcnt(4) lgkmcnt(0)
    v_mfma_f32_16x16x16_bf16 v[72:75], v[86:87], v[94:95], v[104:107]
    v_rcp_f32 v56, v56
    v_mfma_f32_16x16x16_bf16 v[80:83], v[90:91], v[94:95], v[104:107]
    v_rcp_f32 v57, v57
    v_mfma_f32_16x16x32_bf16 v[72:75], v[16:19], v[24:27], v[72:75]
    v_rcp_f32 v58, v58
    v_mfma_f32_16x16x32_bf16 v[80:83], v[16:19], v[32:35], v[80:83]
    v_rcp_f32 v59, v59
    v_rcp_f32 v64, v64
    v_rcp_f32 v65, v65
    v_rcp_f32 v66, v66
    v_rcp_f32 v67, v67
    v_pk_fma_f32 v[108:109], v[68:69], v[56:57], v[108:109]
    v_pk_fma_f32 v[112:113], v[52:53], v[56:57], v[112:113]
    v_pk_fma_f32 v[110:111], v[70:71], v[58:59], v[110:111]
    v_pk_fma_f32 v[114:115], v[54:55], v[58:59], v[114:115]
    v_pk_fma_f32 v[108:109], v[76:77], v[64:65], v[108:109]
    v_pk_fma_f32 v[112:113], v[60:61], v[64:65], v[112:113]
    v_pk_fma_f32 v[110:111], v[78:79], v[66:67], v[110:111]
    v_pk_fma_f32 v[114:115], v[62:63], v[66:67], v[114:115]
    s_branch K2_LOOPF
K2_PSW0:
    s_add_u32 s80, s80, 1
    s_nop 0
    v_readlane_b32 s36, v12, s80
    v_readlane_b32 s81, v7, s80
    s_nop 0
    v_bfe_u32 v4, s36, v13, 8
    s_sub_u32 s81, s81, 3
    v_mad_u32_u24 v4, v4, s93, 32
    s_branch K2_PSR0
K2_PSW1:
    s_add_u32 s80, s80, 1
    s_nop 0
    v_readlane_b32 s36, v12, s80
    v_readlane_b32 s81, v7, s80
    s_nop 0
    v_bfe_u32 v4, s36, v13, 8
    s_sub_u32 s81, s81, 3
    v_mad_u32_u24 v4, v4, s93, 16
    s_branch K2_PSR1
K2_PSW2:
    s_add_u32 s80, s80, 1
    s_nop 0
    v_readlane_b32 s36, v12, s80
    v_readlane_b32 s81, v7, s80
    s_nop 0
    v_bfe_u32 v4, s36, v13, 8
    s_sub_u32 s81, s81, 3
    v_mad_u32_u24 v4, v4, s93, 0
    s_branch K2_PSR2
K2_BND0F:
    s_waitcnt lgkmcnt(0)
    v_bfe_u32 v5, s39, v15, 8
    v_mad_u32_u24 v5, v5, s88, 32
    s_mov_b64 exec, s[44:45]
    ds_read_b128 v[84:87], v5 offset:33504
    ds_read_b128 v[88:91], v5 offset:33520
    s_mov_b64 exec, -1
    v_and_b32 v107, 0xffff0000, v93
    v_lshlrev_b32 v106, 16, v93
    v_and_b32 v105, 0xffff0000, v92
    v_lshlrev_b32 v104, 16, v92
    v_pk_add_f32 v[104:105], v[104:105], s[94:95] op_sel:[0,1] op_sel_hi:[1,1]
    v_pk_add_f32 v[106:107], v[106:107], s[94:95] op_sel:[0,1] op_sel_hi:[1,1]
    s_mov_b32 s37, 0
    v_rcp_f32 v32, v32
    v_rcp_f32 v33, v33
    v_rcp_f32 v34, v34
    v_rcp_f32 v35, v35
    s_waitcnt vmcnt(4) lgkmcnt(0)
    v_mfma_f32_16x16x16_bf16 v[72:75], v[86:87], v[94:95], v[104:107]
    v_rcp_f32 v24, v24
    v_mfma_f32_16x16x16_bf16 v[80:83], v[90:91], v[94:95], v[104:107]
    v_rcp_f32 v25, v25
    v_mfma_f32_16x16x32_bf16 v[72:75], v[16:19], v[40:43], v[72:75]
    v_rcp_f32 v26, v26
    v_mfma_f32_16x16x32_bf16 v[80:83], v[16:19], v[48:51], v[80:83]
    v_rcp_f32 v27, v27
    v_pk_fma_f32 v[108:109], v[68:69], v[24:25], v[108:109]
    v_pk_fma_f32 v[112:113], v[20:21], v[24:25], v[112:113]
    v_pk_fma_f32 v[110:111], v[70:71], v[26:27], v[110:111]
    v_pk_fma_f32 v[114:115], v[22:23], v[26:27], v[114:115]
    v_pk_fma_f32 v[108:109], v[76:77], v[32:33], v[108:109]
    v_pk_fma_f32 v[112:113], v[28:29], v[32:33], v[112:113]
    v_pk_fma_f32 v[110:111], v[78:79], v[34:35], v[110:111]
    v_pk_fma_f32 v[114:115], v[30:31], v[34:35], v[114:115]
    s_branch K2_BCF
K2_BND1F:
    s_waitcnt lgkmcnt(0)
    v_bfe_u32 v5, s39, v15, 8
    v_mad_u32_u24 v5, v5, s88, 0
    s_mov_b64 exec, s[44:45]
    ds_read_b128 v[84:87], v5 offset:33536
    ds_read_b128 v[88:91], v5 offset:33552
    s_mov_b64 exec, -1
    v_and_b32 v107, 0xffff0000, v93
    v_lshlrev_b32 v106, 16, v93
    v_and_b32 v105, 0xffff0000, v92
    v_lshlrev_b32 v104, 16, v92
    v_pk_add_f32 v[104:105], v[104:105], s[94:95] op_sel:[0,1] op_sel_hi:[1,1]
    v_pk_add_f32 v[106:107], v[106:107], s[94:95] op_sel:[0,1] op_sel_hi:[1,1]
    s_mov_b32 s37, 1
    v_rcp_f32 v48, v48
    v_rcp_f32 v49, v49
    v_rcp_f32 v50, v50
    v_rcp_f32 v51, v51
    s_waitcnt vmcnt(4) lgkmcnt(0)
    v_mfma_f32_16x16x16_bf16 v[72:75], v[86:87], v[94:95], v[104:107]
    v_rcp_f32 v40, v40
    v_mfma_f32_16x16x16_bf16 v[80:83], v[90:91], v[94:95], v[104:107]
    v_rcp_f32 v41, v41
    v_mfma_f32_16x16x32_bf16 v[72:75], v[16:19], v[56:59], v[72:75]
    v_rcp_f32 v42, v42
    v_mfma_f32_16x16x32_bf16 v[80:83], v[16:19], v[64:67], v[80:83]
    v_rcp_f32 v43, v43
    v_pk_fma_f32 v[108:109], v[68:69], v[40:41], v[108:109]
    v_pk_fma_f32 v[112:113], v[36:37], v[40:41], v[112:113]
    v_pk_fma_f32 v[110:111], v[70:71], v[42:43], v[110:111]
    v_pk_fma_f32 v[114:115], v[38:39], v[42:43], v[114:115]
    v_pk_fma_f32 v[108:109], v[76:77], v[48:49], v[108:109]
    v_pk_fma_f32 v[112:113], v[44:45], v[48:49], v[112:113]
    v_pk_fma_f32 v[110:111], v[78:79], v[50:51], v[110:111]
    v_pk_fma_f32 v[114:115], v[46:47], v[50:51], v[114:115]
    s_branch K2_BCF
K2_BND2F:
    s_waitcnt lgkmcnt(0)
    v_bfe_u32 v5, s39, v15, 8
    v_mad_u32_u24 v5, v5, s88, 64
    s_mov_b64 exec, s[44:45]
    ds_read_b128 v[84:87], v5 offset:33472
    ds_read_b128 v[88:91], v5 offset:33488
    s_mov_b64 exec, -1
    v_and_b32 v107, 0xffff0000, v93
    v_lshlrev_b32 v106, 16, v93
    v_and_b32 v105, 0xffff0000, v92
    v_lshlrev_b32 v104, 16, v92
    v_pk_add_f32 v[104:105], v[104:105], s[94:95] op_sel:[0,1] op_sel_hi:[1,1]
    v_pk_add_f32 v[106:107], v[106:107], s[94:95] op_sel:[0,1] op_sel_hi:[1,1]
    s_mov_b32 s37, 2
    v_rcp_f32 v64, v64
    v_rcp_f32 v65, v65
    v_rcp_f32 v66, v66
    v_rcp_f32 v67, v67
    s_waitcnt vmcnt(4) lgkmcnt(0)
    v_mfma_f32_16x16x16_bf16 v[72:75], v[86:87], v[94:95], v[104:107]
    v_rcp_f32 v56, v56
    v_mfma_f32_16x16x16_bf16 v[80:83], v[90:91], v[94:95], v[104:107]
    v_rcp_f32 v57, v57
    v_mfma_f32_16x16x32_bf16 v[72:75], v[16:19], v[24:27], v[72:75]
    v_rcp_f32 v58, v58
    v_mfma_f32_16x16x32_bf16 v[80:83], v[16:19], v[32:35], v[80:83]
    v_rcp_f32 v59, v59
    v_pk_fma_f32 v[108:109], v[68:69], v[56:57], v[108:109]
    v_pk_fma_f32 v[112:113], v[52:53], v[56:57], v[112:113]
    v_pk_fma_f32 v[110:111], v[70:71], v[58:59], v[110:111]
    v_pk_fma_f32 v[114:115], v[54:55], v[58:59], v[114:115]
    v_pk_fma_f32 v[108:109], v[76:77], v[64:65], v[108:109]
    v_pk_fma_f32 v[112:113], v[60:61], v[64:65], v[112:113]
    v_pk_fma_f32 v[110:111], v[78:79], v[66:67], v[110:111]
    v_pk_fma_f32 v[114:115], v[62:63], v[66:67], v[114:115]
K2_BCF:
    s_cmp_eq_u32 s46, 0
    s_cbranch_scc1 K2_FIN
    s_lshl_b32 s100, s86, 2
    s_add_u32 s100, s100, 163104
    s_sub_u32 s101, s84, s47
    s_add_u32 s66, s101, 256
    v_mov_b32 v10, s100
    v_mov_b32 v11, s66
    s_mov_b64 exec, 1
    ds_add_rtn_u32 v11, v10, v11
    s_mov_b64 exec, -1
    v_cmp_ge_u32 vcc, s92, v123
    s_bcnt1_i32_b64 s64, vcc
    s_add_u32 s101, s101, s92
    s_waitcnt lgkmcnt(0)
    v_readfirstlane_b32 s100, v11
    s_and_b32 s65, s100, 0xff
    s_add_u32 s65, s65, s101
    s_bfe_u32 s66, s100, 0x80008
    s_cmp_eq_u32 s65, s91
    s_cbranch_scc1 K2_LAST
    s_add_u32 s64, s64, s66
    s_lshl_b32 s64, s64, 11
    s_add_u32 s64, s64, 84288
    v_lshl_add_u32 v6, v1, 4, s64
    v_mov_b32 v11, 0x10000
    ds_write_b128 v6, v[108:111]
    ds_write_b128 v6, v[112:115] offset:1024
    s_mov_b64 exec, 1
    ds_add_u32 v10, v11
    s_mov_b64 exec, -1
    s_branch K2_NXTF
K2_LWAIT:
    ds_read_b32 v11, v10
    s_waitcnt lgkmcnt(0)
    v_readfirstlane_b32 s100, v11
K2_LAST:
    s_lshr_b32 s65, s100, 16
    s_cmp_lg_u32 s65, s66
    s_cbranch_scc1 K2_LWAIT
    s_lshl_b32 s64, s64, 11
    s_add_u32 s64, s64, 84288
K2_SUM:
    v_lshl_add_u32 v6, v1, 4, s64
    ds_read_b128 v[68:71], v6
    ds_read_b128 v[76:79], v6 offset:1024
    s_add_u32 s64, s64, 2048
    s_sub_u32 s66, s66, 1
    s_waitcnt lgkmcnt(0)
    v_pk_add_f32 v[108:109], v[108:109], v[68:69]
    v_pk_add_f32 v[110:111], v[110:111], v[70:71]
    v_pk_add_f32 v[112:113], v[112:113], v[76:77]
    v_pk_add_f32 v[114:115], v[114:115], v[78:79]
    s_cmp_lg_u32 s66, 0
    s_cbranch_scc1 K2_SUM
K2_FIN:
    v_rcp_f32 v108, v108
    v_rcp_f32 v109, v109
    v_rcp_f32 v110, v110
    v_rcp_f32 v111, v111
    v_cmp_gt_u32 vcc, s59, v122
    v_lshlrev_b32 v68, 16, v120
    v_and_b32 v69, 0xffff0000, v120
    v_lshlrev_b32 v70, 16, v121
    v_and_b32 v71, 0xffff0000, v121
    v_pk_fma_f32 v[68:69], v[108:109], v[112:113], v[68:69]
    v_pk_fma_f32 v[70:71], v[110:111], v[114:115], v[70:71]
    v_lshlrev_b32 v76, 16, v116
    v_max_f32 v68, 0, v68
    v_and_b32 v77, 0xffff0000, v116
    v_max_f32 v69, 0, v69
    v_lshlrev_b32 v78, 16, v117
    v_max_f32 v70, 0, v70
    v_and_b32 v79, 0xffff0000, v117
    v_max_f32 v71, 0, v71
    v_pk_add_f32 v[68:69], v[68:69], v[76:77]
    v_pk_add_f32 v[70:71], v[70:71], v[78:79]
    v_cvt_pk_bf16_f32 v118, v68, v69
    v_cvt_pk_bf16_f32 v119, v70, v71
    s_mov_b64 exec, vcc
    buffer_store_dwordx2 v[118:119], v122, s[52:55], s58 offen sc1
    s_mov_b64 exec, -1
K2_NXTF:
    s_cmp_ge_u32 s84, s85
    s_cbranch_scc1 K2_MAIN_ENDF
    s_add_u32 s86, s86, 1
    s_mov_b32 s92, s91
    s_add_u32 s36, s86, 1
    v_readlane_b32 s91, v7, s86
    v_mov_b32 v122, v99
    v_readlane_b32 s39, v12, s36
    ds_read_b64 v[120:121], v98 offset:12800
    buffer_load_dwordx2 v[116:117], v99, s[48:51], s58 offen
    s_mov_b32 s47, s84
    s_min_u32 s87, s91, s85
    s_cmp_lt_u32 s92, s84
    s_cselect_b32 s46, 1, 0
    s_cselect_b32 s100, 0, s56
    s_cmp_gt_u32 s91, s85
    s_cselect_b32 s46, 1, s46
    v_mov_b32 v108, s100
    v_mov_b32 v109, s100
    v_mov_b32 v110, s100
    v_mov_b32 v111, s100
    v_mov_b64 v[112:113], 0
    v_mov_b64 v[114:115], 0
    v_bfe_u32 v96, s39, v13, 8
    v_xor_b32 v98, v96, v9
    v_and_b32 v98, 15, v98
    v_lshl_add_u32 v98, v98, 3, s90
    v_lshl_add_u32 v98, v96, 7, v98
    v_lshl_add_u32 v99, v96, 8, v127
    ds_read_b64 v[92:93], v98
    s_cmp_eq_u32 s37, 0
    s_cbranch_scc1 K2_STEP1F
    s_cmp_eq_u32 s37, 1
    s_cbranch_scc1 K2_STEP2F
    s_branch K2_STEP0F
K2_MAIN_ENDF:
    s_endpgm
K2_REDO2:
    s_waitcnt lgkmcnt(0)
    v_lshlrev_b32 v12, 9, v1
    v_mov_b32 v13, 163072
    v_and_b32 v15, 7, v1
    v_mul_u32_u24 v15, 37632, v15
    s_branch K2_REDO
K2_GENERIC:
    ds_read_b32 v7, v3 offset:4352
    s_mov_b64 exec, s[64:65]
    ds_read_b32 v84, v84 offset:1280
    s_mov_b64 exec, s[66:67]
    ds_read_b32 v85, v85 offset:1280
    s_mov_b64 exec, s[68:69]
    ds_read_b32 v86, v86 offset:1280
    s_mov_b64 exec, s[70:71]
    ds_read_b32 v87, v87 offset:1280
    s_mov_b64 exec, -1
    s_cmp_eq_u32 s96, 0
    s_cbranch_scc1 K2_SK_PB1
    s_mov_b64 exec, s[72:73]
    ds_read_b32 v88, v88 offset:1280
    s_mov_b64 exec, s[74:75]
    ds_read_b32 v89, v89 offset:1280
    s_mov_b64 exec, s[76:77]
    ds_read_b32 v90, v90 offset:1280
    s_mov_b64 exec, s[78:79]
    ds_read_b32 v91, v91 offset:1280
    s_mov_b64 exec, -1
K2_SK_PB1:
    s_waitcnt lgkmcnt(0)
    v_readlane_b32 s83, v7, 24
    s_cmp_gt_u32 s83, 240
    s_cbranch_scc0 K2_FIT
    s_mov_b32 s81, 4
K2_REDO:
    s_waitcnt vmcnt(0) lgkmcnt(0)
    s_barrier
    s_branch K2_ROUND
K2_FIT:
    s_lshr_b32 s97, s83, 4
    s_and_b32 s98, s83, 15
    s_mul_i32 s84, s97, s3
    s_min_u32 s85, s3, s98
    s_add_u32 s84, s84, s85
    s_cmp_lt_u32 s3, s98
    s_addc_u32 s85, s84, s97
    v_cmp_ge_u32 vcc, s84, v7
    s_bcnt1_i32_b64 s86, vcc
    s_lshl_b32 s99, s86, 5
    v_lshl_add_u32 v124, v8, 3, s99
    ds_read_b64 v[96:97], v124 offset:2304
    v_add_u32 v55, v55, v84
    v_add_u32 v59, v59, v85
    v_add_u32 v63, v63, v86
    v_add_u32 v67, v67, v87
    s_mov_b64 exec, s[64:65]
    ds_write_b16 v55, v54 offset:5888
    s_mov_b64 exec, s[66:67]
    ds_write_b16 v59, v58 offset:5888
    s_mov_b64 exec, s[68:69]
    ds_write_b16 v63, v62 offset:5888
    s_mov_b64 exec, s[70:71]
    ds_write_b16 v67, v66 offset:5888
    s_mov_b64 exec, -1
    s_cmp_eq_u32 s96, 0
    s_cbranch_scc1 K2_SK_PB2
    v_add_u32 v71, v71, v88
    v_add_u32 v75, v75, v89
    v_add_u32 v79, v79, v90
    v_add_u32 v83, v83, v91
    s_mov_b64 exec, s[72:73]
    ds_write_b16 v71, v70 offset:5888
    s_mov_b64 exec, s[74:75]
    ds_write_b16 v75, v74 offset:5888
    s_mov_b64 exec, s[76:77]
    ds_write_b16 v79, v78 offset:5888
    s_mov_b64 exec, s[78:79]
    ds_write_b16 v83, v82 offset:5888
    s_mov_b64 exec, -1
K2_SK_PB2:
    s_lshl_b32 s100, s84, 6
    v_add_u32 v4, s100, v4
    s_cmp_lg_u32 s39, 0
    s_cbranch_scc1 K2_NOGZ
    s_mov_b32 s39, 1
    v_lshlrev_b32 v10, 4, v0
    v_add_u32 v10, 21248, v10
    v_mov_b32 v20, 0
    v_mov_b32 v21, 0
    v_mov_b32 v22, 0
    v_mov_b32 v23, 0
    ds_write_b128 v10, v[20:23] offset:0
    ds_write_b128 v10, v[20:23] offset:16384
    ds_write_b128 v10, v[20:23] offset:32768
    v_add_u32 v10, 49152, v10
    ds_write_b128 v10, v[20:23] offset:0
    ds_write_b128 v10, v[20:23] offset:16384
    s_waitcnt lgkmcnt(0)
    s_barrier
K2_NOGZ:
    v_lshlrev_b32 v55, 1, v55
    v_lshlrev_b32 v59, 1, v59
    v_lshlrev_b32 v63, 1, v63
    v_lshlrev_b32 v67, 1, v67
    s_mov_b64 exec, s[64:65]
    ds_write_b64 v55, v[52:53] offset:21248
    s_mov_b64 exec, s[66:67]
    ds_write_b64 v59, v[56:57] offset:21248
    s_mov_b64 exec, s[68:69]
    ds_write_b64 v63, v[60:61] offset:21248
    s_mov_b64 exec, s[70:71]
    ds_write_b64 v67, v[64:65] offset:21248
    s_mov_b64 exec, -1
    s_cmp_eq_u32 s96, 0
    s_cbranch_scc1 K2_SK_PB3
    v_lshlrev_b32 v71, 1, v71
    v_lshlrev_b32 v75, 1, v75
    v_lshlrev_b32 v79, 1, v79
    v_lshlrev_b32 v83, 1, v83
    s_mov_b64 exec, s[72:73]
    ds_write_b64 v71, v[68:69] offset:21248
    s_mov_b64 exec, s[74:75]
    ds_write_b64 v75, v[72:73] offset:21248
    s_mov_b64 exec, s[76:77]
    ds_write_b64 v79, v[76:77] offset:21248
    s_mov_b64 exec, s[78:79]
    ds_write_b64 v83, v[80:81] offset:21248
    s_mov_b64 exec, -1
K2_SK_PB3:
    s_lshl_b32 s100, s84, 7
    v_add_u32 v5, s100, v5
    s_sub_u32 s97, s86, 1
    s_max_i32 s97, s97, 0
    s_nop 0
    v_readlane_b32 s92, v7, s97
    s_cmp_eq_u32 s86, 0
    s_cselect_b32 s92, 0, s92
    v_mov_b64 v[84:85], 0
    v_mov_b64 v[86:87], 0
    v_mov_b64 v[88:89], 0
    v_mov_b64 v[90:91], 0
    s_sub_u32 s96, s85, 2
    s_max_i32 s96, s96, 0
    s_sub_u32 s97, s85, 6
    s_sub_u32 s98, s85, 3
    s_sub_u32 s99, s85, 1
    s_waitcnt lgkmcnt(0)
    v_xor_b32 v98, v97, v127
    v_add_u32 v99, v96, v127
    v_add_u32 v124, 32, v124
    ds_read_b64 v[92:93], v98
    ds_read_b64 v[96:97], v124 offset:2304
    s_waitcnt lgkmcnt(0)
    v_and_b32 v107, 0xffff0000, v93
    v_lshlrev_b32 v106, 16, v93
    v_and_b32 v105, 0xffff0000, v92
    v_lshlrev_b32 v104, 16, v92
    v_pk_add_f32 v[104:105], v[104:105], s[94:95] op_sel:[0,1] op_sel_hi:[1,1]
    v_pk_add_f32 v[106:107], v[106:107], s[94:95] op_sel:[0,1] op_sel_hi:[1,1]
    s_barrier
    s_cmp_ge_u32 s84, s85
    s_cbranch_scc1 K2_MAIN_ENDG
    ds_read_b128 v[100:103], v4 offset:0
    ds_read_b128 v[68:71], v4 offset:64
    s_mov_b64 exec, s[44:45]
    ds_read_b128 v[84:87], v5 offset:0
    ds_read_b128 v[88:91], v5 offset:16
    s_mov_b64 exec, -1
    s_waitcnt lgkmcnt(3)
    v_lshl_add_u32 v100, v100, 8, v2
    v_lshl_add_u32 v101, v101, 8, v2
    v_lshl_add_u32 v102, v102, 8, v2
    v_lshl_add_u32 v103, v103, 8, v2
    buffer_load_dwordx4 v[20:23], v100, s[32:35], 0 offen sc1
    buffer_load_dwordx4 v[24:27], v101, s[32:35], 0 offen sc1
    buffer_load_dwordx4 v[28:31], v102, s[32:35], 0 offen sc1
    buffer_load_dwordx4 v[32:35], v103, s[32:35], 0 offen sc1
    s_waitcnt lgkmcnt(2)
    v_lshl_add_u32 v68, v68, 8, v2
    v_lshl_add_u32 v69, v69, 8, v2
    v_lshl_add_u32 v70, v70, 8, v2
    v_lshl_add_u32 v71, v71, 8, v2
    buffer_load_dwordx4 v[36:39], v68, s[32:35], 0 offen sc1
    buffer_load_dwordx4 v[40:43], v69, s[32:35], 0 offen sc1
    buffer_load_dwordx4 v[44:47], v70, s[32:35], 0 offen sc1
    buffer_load_dwordx4 v[48:51], v71, s[32:35], 0 offen sc1
    ds_read_b128 v[100:103], v4 offset:128
    v_readlane_b32 s91, v7, s86
    v_mov_b32 v122, v99
    s_mov_b32 s47, s84
    s_min_u32 s87, s91, s85
    s_cmp_lt_u32 s92, s84
    s_cselect_b32 s46, 1, 0
    s_cmp_gt_u32 s91, s85
    s_cselect_b32 s46, 1, s46
    v_mov_b32 v108, 0
    v_mov_b32 v109, 0
    v_mov_b32 v110, 0
    v_mov_b32 v111, 0
    v_mov_b32 v112, 0
    v_mov_b32 v113, 0
    v_mov_b32 v114, 0
    v_mov_b32 v115, 0
    v_xor_b32 v98, v97, v127
    v_add_u32 v99, v96, v127
    v_add_u32 v124, 32, v124
    ds_read_b64 v[92:93], v98
    ds_read_b64 v[96:97], v124 offset:2304
    v_add_u32 v6, 51968, v122
    v_add_u32 v6, v6, v127
    s_cmp_lg_u32 s46, 0
    s_cbranch_scc1 K2_SGAG
    ds_read_b128 v[108:111], v6
    ds_read_b128 v[112:115], v6 offset:25600
K2_SGAG:
    s_waitcnt vmcnt(4) lgkmcnt(0)
    v_mfma_f32_16x16x16_bf16 v[72:75], v[86:87], v[94:95], v[104:107]
    v_mfma_f32_16x16x16_bf16 v[80:83], v[90:91], v[94:95], v[104:107]
    v_mfma_f32_16x16x32_bf16 v[72:75], v[16:19], v[24:27], v[72:75]
    v_mfma_f32_16x16x32_bf16 v[80:83], v[16:19], v[32:35], v[80:83]
    s_nop 6
.p2align 6
K2_LOOPG:
K2_STEP0G:
    v_mfma_f32_16x16x16_bf16 v[68:71], v[84:85], v[94:95], v[104:107]
    v_exp_f32_e64 v72, v72 clamp
    v_mfma_f32_16x16x16_bf16 v[76:79], v[88:89], v[94:95], v[104:107]
    v_exp_f32_e64 v73, v73 clamp
    v_mfma_f32_16x16x32_bf16 v[68:71], v[16:19], v[20:23], v[68:71]
    v_exp_f32_e64 v74, v74 clamp
    v_mfma_f32_16x16x32_bf16 v[76:79], v[16:19], v[28:31], v[76:79]
    v_exp_f32_e64 v75, v75 clamp
    v_exp_f32_e64 v80, v80 clamp
    v_exp_f32_e64 v81, v81 clamp
    v_exp_f32_e64 v82, v82 clamp
    v_exp_f32_e64 v83, v83 clamp
    s_cmp_lt_u32 s84, s96
    s_cselect_b64 exec, -1, 1
    v_lshl_add_u32 v100, v100, 8, v2
    v_lshl_add_u32 v101, v101, 8, v2
    v_lshl_add_u32 v102, v102, 8, v2
    v_lshl_add_u32 v103, v103, 8, v2
    buffer_load_dwordx4 v[52:55], v100, s[32:35], 0 offen sc1
    buffer_load_dwordx4 v[56:59], v101, s[32:35], 0 offen sc1
    buffer_load_dwordx4 v[60:63], v102, s[32:35], 0 offen sc1
    buffer_load_dwordx4 v[64:67], v103, s[32:35], 0 offen sc1
    s_mov_b64 exec, -1
    ds_read_b128 v[100:103], v4 offset:192
    s_mov_b64 exec, s[44:45]
    ds_read_b128 v[84:87], v5 offset:128
    ds_read_b128 v[88:91], v5 offset:144
    s_mov_b64 exec, -1
    s_add_u32 s84, s84, 1
    v_exp_f32_e64 v68, v68 clamp
    v_exp_f32_e64 v69, v69 clamp
    v_exp_f32_e64 v70, v70 clamp
    v_exp_f32_e64 v71, v71 clamp
    v_exp_f32_e64 v76, v76 clamp
    v_exp_f32_e64 v77, v77 clamp
    v_exp_f32_e64 v78, v78 clamp
    v_exp_f32_e64 v79, v79 clamp
    v_pk_add_f32 v[72:73], v[72:73], s[94:95] op_sel_hi:[1,0]
    v_pk_add_f32 v[74:75], v[74:75], s[94:95] op_sel_hi:[1,0]
    v_pk_add_f32 v[80:81], v[80:81], s[94:95] op_sel_hi:[1,0]
    v_pk_add_f32 v[82:83], v[82:83], s[94:95] op_sel_hi:[1,0]
    v_pk_add_f32 v[68:69], v[68:69], s[94:95] op_sel_hi:[1,0]
    v_pk_add_f32 v[70:71], v[70:71], s[94:95] op_sel_hi:[1,0]
    v_pk_add_f32 v[76:77], v[76:77], s[94:95] op_sel_hi:[1,0]
    v_pk_add_f32 v[78:79], v[78:79], s[94:95] op_sel_hi:[1,0]
    v_pk_mul_f32 v[20:21], v[20:21], v[72:73]
    v_pk_mul_f32 v[22:23], v[22:23], v[74:75]
    v_pk_mul_f32 v[28:29], v[28:29], v[80:81]
    v_pk_mul_f32 v[30:31], v[30:31], v[82:83]
    v_pk_fma_f32 v[20:21], v[24:25], v[68:69], v[20:21]
    v_pk_fma_f32 v[22:23], v[26:27], v[70:71], v[22:23]
    v_pk_fma_f32 v[28:29], v[32:33], v[76:77], v[28:29]
    v_pk_fma_f32 v[30:31], v[34:35], v[78:79], v[30:31]
    v_pk_mul_f32 v[24:25], v[68:69], v[72:73]
    v_pk_mul_f32 v[26:27], v[70:71], v[74:75]
    v_pk_mul_f32 v[32:33], v[76:77], v[80:81]
    v_pk_mul_f32 v[34:35], v[78:79], v[82:83]
    v_pk_add_f32 v[68:69], v[68:69], v[72:73]
    v_pk_add_f32 v[70:71], v[70:71], v[74:75]
    v_pk_add_f32 v[76:77], v[76:77], v[80:81]
    v_pk_add_f32 v[78:79], v[78:79], v[82:83]
    s_cmp_ge_u32 s84, s87
    s_cbranch_scc1 K2_BND0G
    s_waitcnt vmcnt(4) lgkmcnt(0)
    v_mfma_f32_16x16x16_bf16 v[72:75], v[86:87], v[94:95], v[104:107]
    v_rcp_f32 v24, v24
    v_mfma_f32_16x16x16_bf16 v[80:83], v[90:91], v[94:95], v[104:107]
    v_rcp_f32 v25, v25
    v_mfma_f32_16x16x32_bf16 v[72:75], v[16:19], v[40:43], v[72:75]
    v_rcp_f32 v26, v26
    v_mfma_f32_16x16x32_bf16 v[80:83], v[16:19], v[48:51], v[80:83]
    v_rcp_f32 v27, v27
    v_rcp_f32 v32, v32
    v_rcp_f32 v33, v33
    v_rcp_f32 v34, v34
    v_rcp_f32 v35, v35
    v_pk_fma_f32 v[108:109], v[68:69], v[24:25], v[108:109]
    v_pk_fma_f32 v[112:113], v[20:21], v[24:25], v[112:113]
    v_pk_fma_f32 v[110:111], v[70:71], v[26:27], v[110:111]
    v_pk_fma_f32 v[114:115], v[22:23], v[26:27], v[114:115]
    v_pk_fma_f32 v[108:109], v[76:77], v[32:33], v[108:109]
    v_pk_fma_f32 v[112:113], v[28:29], v[32:33], v[112:113]
    v_pk_fma_f32 v[110:111], v[78:79], v[34:35], v[110:111]
    v_pk_fma_f32 v[114:115], v[30:31], v[34:35], v[114:115]
K2_STEP1G:
    v_mfma_f32_16x16x16_bf16 v[68:71], v[84:85], v[94:95], v[104:107]
    v_exp_f32_e64 v72, v72 clamp
    v_mfma_f32_16x16x16_bf16 v[76:79], v[88:89], v[94:95], v[104:107]
    v_exp_f32_e64 v73, v73 clamp
    v_mfma_f32_16x16x32_bf16 v[68:71], v[16:19], v[36:39], v[68:71]
    v_exp_f32_e64 v74, v74 clamp
    v_mfma_f32_16x16x32_bf16 v[76:79], v[16:19], v[44:47], v[76:79]
    v_exp_f32_e64 v75, v75 clamp
    v_exp_f32_e64 v80, v80 clamp
    v_exp_f32_e64 v81, v81 clamp
    v_exp_f32_e64 v82, v82 clamp
    v_exp_f32_e64 v83, v83 clamp
    s_cmp_lt_u32 s84, s96
    s_cselect_b64 exec, -1, 1
    v_lshl_add_u32 v100, v100, 8, v2
    v_lshl_add_u32 v101, v101, 8, v2
    v_lshl_add_u32 v102, v102, 8, v2
    v_lshl_add_u32 v103, v103, 8, v2
    buffer_load_dwordx4 v[20:23], v100, s[32:35], 0 offen sc1
    buffer_load_dwordx4 v[24:27], v101, s[32:35], 0 offen sc1
    buffer_load_dwordx4 v[28:31], v102, s[32:35], 0 offen sc1
    buffer_load_dwordx4 v[32:35], v103, s[32:35], 0 offen sc1
    s_mov_b64 exec, -1
    ds_read_b128 v[100:103], v4 offset:256
    s_mov_b64 exec, s[44:45]
    ds_read_b128 v[84:87], v5 offset:256
    ds_read_b128 v[88:91], v5 offset:272
    s_mov_b64 exec, -1
    s_add_u32 s84, s84, 1
    v_exp_f32_e64 v68, v68 clamp
    v_exp_f32_e64 v69, v69 clamp
    v_exp_f32_e64 v70, v70 clamp
    v_exp_f32_e64 v71, v71 clamp
    v_exp_f32_e64 v76, v76 clamp
    v_exp_f32_e64 v77, v77 clamp
    v_exp_f32_e64 v78, v78 clamp
    v_exp_f32_e64 v79, v79 clamp
    v_pk_add_f32 v[72:73], v[72:73], s[94:95] op_sel_hi:[1,0]
    v_pk_add_f32 v[74:75], v[74:75], s[94:95] op_sel_hi:[1,0]
    v_pk_add_f32 v[80:81], v[80:81], s[94:95] op_sel_hi:[1,0]
    v_pk_add_f32 v[82:83], v[82:83], s[94:95] op_sel_hi:[1,0]
    v_pk_add_f32 v[68:69], v[68:69], s[94:95] op_sel_hi:[1,0]
    v_pk_add_f32 v[70:71], v[70:71], s[94:95] op_sel_hi:[1,0]
    v_pk_add_f32 v[76:77], v[76:77], s[94:95] op_sel_hi:[1,0]
    v_pk_add_f32 v[78:79], v[78:79], s[94:95] op_sel_hi:[1,0]
    v_pk_mul_f32 v[36:37], v[36:37], v[72:73]
    v_pk_mul_f32 v[38:39], v[38:39], v[74:75]
    v_pk_mul_f32 v[44:45], v[44:45], v[80:81]
    v_pk_mul_f32 v[46:47], v[46:47], v[82:83]
    v_pk_fma_f32 v[36:37], v[40:41], v[68:69], v[36:37]
    v_pk_fma_f32 v[38:39], v[42:43], v[70:71], v[38:39]
    v_pk_fma_f32 v[44:45], v[48:49], v[76:77], v[44:45]
    v_pk_fma_f32 v[46:47], v[50:51], v[78:79], v[46:47]
    v_pk_mul_f32 v[40:41], v[68:69], v[72:73]
    v_pk_mul_f32 v[42:43], v[70:71], v[74:75]
    v_pk_mul_f32 v[48:49], v[76:77], v[80:81]
    v_pk_mul_f32 v[50:51], v[78:79], v[82:83]
    v_pk_add_f32 v[68:69], v[68:69], v[72:73]
    v_pk_add_f32 v[70:71], v[70:71], v[74:75]
    v_pk_add_f32 v[76:77], v[76:77], v[80:81]
    v_pk_add_f32 v[78:79], v[78:79], v[82:83]
    s_cmp_ge_u32 s84, s87
    s_cbranch_scc1 K2_BND1G
    s_waitcnt vmcnt(4) lgkmcnt(0)
    v_mfma_f32_16x16x16_bf16 v[72:75], v[86:87], v[94:95], v[104:107]
    v_rcp_f32 v40, v40
    v_mfma_f32_16x16x16_bf16 v[80:83], v[90:91], v[94:95], v[104:107]
    v_rcp_f32 v41, v41
    v_mfma_f32_16x16x32_bf16 v[72:75], v[16:19], v[56:59], v[72:75]
    v_rcp_f32 v42, v42
    v_mfma_f32_16x16x32_bf16 v[80:83], v[16:19], v[64:67], v[80:83]
    v_rcp_f32 v43, v43
    v_rcp_f32 v48, v48
    v_rcp_f32 v49, v49
    v_rcp_f32 v50, v50
    v_rcp_f32 v51, v51
    v_pk_fma_f32 v[108:109], v[68:69], v[40:41], v[108:109]
    v_pk_fma_f32 v[112:113], v[36:37], v[40:41], v[112:113]
    v_pk_fma_f32 v[110:111], v[70:71], v[42:43], v[110:111]
    v_pk_fma_f32 v[114:115], v[38:39], v[42:43], v[114:115]
    v_pk_fma_f32 v[108:109], v[76:77], v[48:49], v[108:109]
    v_pk_fma_f32 v[112:113], v[44:45], v[48:49], v[112:113]
    v_pk_fma_f32 v[110:111], v[78:79], v[50:51], v[110:111]
    v_pk_fma_f32 v[114:115], v[46:47], v[50:51], v[114:115]
K2_STEP2G:
    v_mfma_f32_16x16x16_bf16 v[68:71], v[84:85], v[94:95], v[104:107]
    v_exp_f32_e64 v72, v72 clamp
    v_mfma_f32_16x16x16_bf16 v[76:79], v[88:89], v[94:95], v[104:107]
    v_exp_f32_e64 v73, v73 clamp
    v_mfma_f32_16x16x32_bf16 v[68:71], v[16:19], v[52:55], v[68:71]
    v_exp_f32_e64 v74, v74 clamp
    v_mfma_f32_16x16x32_bf16 v[76:79], v[16:19], v[60:63], v[76:79]
    v_exp_f32_e64 v75, v75 clamp
    v_exp_f32_e64 v80, v80 clamp
    v_exp_f32_e64 v81, v81 clamp
    v_exp_f32_e64 v82, v82 clamp
    v_exp_f32_e64 v83, v83 clamp
    s_cmp_lt_u32 s84, s96
    s_cselect_b64 exec, -1, 1
    v_lshl_add_u32 v100, v100, 8, v2
    v_lshl_add_u32 v101, v101, 8, v2
    v_lshl_add_u32 v102, v102, 8, v2
    v_lshl_add_u32 v103, v103, 8, v2
    buffer_load_dwordx4 v[36:39], v100, s[32:35], 0 offen sc1
    buffer_load_dwordx4 v[40:43], v101, s[32:35], 0 offen sc1
    buffer_load_dwordx4 v[44:47], v102, s[32:35], 0 offen sc1
    buffer_load_dwordx4 v[48:51], v103, s[32:35], 0 offen sc1
    s_mov_b64 exec, -1
    ds_read_b128 v[100:103], v4 offset:320
    s_mov_b64 exec, s[44:45]
    ds_read_b128 v[84:87], v5 offset:384
    ds_read_b128 v[88:91], v5 offset:400
    s_mov_b64 exec, -1
    v_add_u32 v4, 192, v4
    v_add_u32 v5, 384, v5
    s_add_u32 s84, s84, 1
    v_exp_f32_e64 v68, v68 clamp
    v_exp_f32_e64 v69, v69 clamp
    v_exp_f32_e64 v70, v70 clamp
    v_exp_f32_e64 v71, v71 clamp
    v_exp_f32_e64 v76, v76 clamp
    v_exp_f32_e64 v77, v77 clamp
    v_exp_f32_e64 v78, v78 clamp
    v_exp_f32_e64 v79, v79 clamp
    v_pk_add_f32 v[72:73], v[72:73], s[94:95] op_sel_hi:[1,0]
    v_pk_add_f32 v[74:75], v[74:75], s[94:95] op_sel_hi:[1,0]
    v_pk_add_f32 v[80:81], v[80:81], s[94:95] op_sel_hi:[1,0]
    v_pk_add_f32 v[82:83], v[82:83], s[94:95] op_sel_hi:[1,0]
    v_pk_add_f32 v[68:69], v[68:69], s[94:95] op_sel_hi:[1,0]
    v_pk_add_f32 v[70:71], v[70:71], s[94:95] op_sel_hi:[1,0]
    v_pk_add_f32 v[76:77], v[76:77], s[94:95] op_sel_hi:[1,0]
    v_pk_add_f32 v[78:79], v[78:79], s[94:95] op_sel_hi:[1,0]
    v_pk_mul_f32 v[52:53], v[52:53], v[72:73]
    v_pk_mul_f32 v[54:55], v[54:55], v[74:75]
    v_pk_mul_f32 v[60:61], v[60:61], v[80:81]
    v_pk_mul_f32 v[62:63], v[62:63], v[82:83]
    v_pk_fma_f32 v[52:53], v[56:57], v[68:69], v[52:53]
    v_pk_fma_f32 v[54:55], v[58:59], v[70:71], v[54:55]
    v_pk_fma_f32 v[60:61], v[64:65], v[76:77], v[60:61]
    v_pk_fma_f32 v[62:63], v[66:67], v[78:79], v[62:63]
    v_pk_mul_f32 v[56:57], v[68:69], v[72:73]
    v_pk_mul_f32 v[58:59], v[70:71], v[74:75]
    v_pk_mul_f32 v[64:65], v[76:77], v[80:81]
    v_pk_mul_f32 v[66:67], v[78:79], v[82:83]
    v_pk_add_f32 v[68:69], v[68:69], v[72:73]
    v_pk_add_f32 v[70:71], v[70:71], v[74:75]
    v_pk_add_f32 v[76:77], v[76:77], v[80:81]
    v_pk_add_f32 v[78:79], v[78:79], v[82:83]
    s_cmp_ge_u32 s84, s87
    s_cbranch_scc1 K2_BND2G
    s_waitcnt vmcnt(4) lgkmcnt(0)
    v_mfma_f32_16x16x16_bf16 v[72:75], v[86:87], v[94:95], v[104:107]
    v_rcp_f32 v56, v56
    v_mfma_f32_16x16x16_bf16 v[80:83], v[90:91], v[94:95], v[104:107]
    v_rcp_f32 v57, v57
    v_mfma_f32_16x16x32_bf16 v[72:75], v[16:19], v[24:27], v[72:75]
    v_rcp_f32 v58, v58
    v_mfma_f32_16x16x32_bf16 v[80:83], v[16:19], v[32:35], v[80:83]
    v_rcp_f32 v59, v59
    v_rcp_f32 v64, v64
    v_rcp_f32 v65, v65
    v_rcp_f32 v66, v66
    v_rcp_f32 v67, v67
    v_pk_fma_f32 v[108:109], v[68:69], v[56:57], v[108:109]
    v_pk_fma_f32 v[112:113], v[52:53], v[56:57], v[112:113]
    v_pk_fma_f32 v[110:111], v[70:71], v[58:59], v[110:111]
    v_pk_fma_f32 v[114:115], v[54:55], v[58:59], v[114:115]
    v_pk_fma_f32 v[108:109], v[76:77], v[64:65], v[108:109]
    v_pk_fma_f32 v[112:113], v[60:61], v[64:65], v[112:113]
    v_pk_fma_f32 v[110:111], v[78:79], v[66:67], v[110:111]
    v_pk_fma_f32 v[114:115], v[62:63], v[66:67], v[114:115]
    s_branch K2_LOOPG
K2_BND0G:
    s_waitcnt lgkmcnt(0)
    v_and_b32 v107, 0xffff0000, v93
    v_lshlrev_b32 v106, 16, v93
    v_and_b32 v105, 0xffff0000, v92
    v_lshlrev_b32 v104, 16, v92
    v_pk_add_f32 v[104:105], v[104:105], s[94:95] op_sel:[0,1] op_sel_hi:[1,1]
    v_pk_add_f32 v[106:107], v[106:107], s[94:95] op_sel:[0,1] op_sel_hi:[1,1]
    s_mov_b32 s37, 0
    s_waitcnt vmcnt(4)
    v_mfma_f32_16x16x16_bf16 v[72:75], v[86:87], v[94:95], v[104:107]
    v_rcp_f32 v24, v24
    v_mfma_f32_16x16x16_bf16 v[80:83], v[90:91], v[94:95], v[104:107]
    v_rcp_f32 v25, v25
    v_mfma_f32_16x16x32_bf16 v[72:75], v[16:19], v[40:43], v[72:75]
    v_rcp_f32 v26, v26
    v_mfma_f32_16x16x32_bf16 v[80:83], v[16:19], v[48:51], v[80:83]
    v_rcp_f32 v27, v27
    v_rcp_f32 v32, v32
    v_rcp_f32 v33, v33
    v_rcp_f32 v34, v34
    v_rcp_f32 v35, v35
    v_pk_fma_f32 v[108:109], v[68:69], v[24:25], v[108:109]
    v_pk_fma_f32 v[112:113], v[20:21], v[24:25], v[112:113]
    v_pk_fma_f32 v[110:111], v[70:71], v[26:27], v[110:111]
    v_pk_fma_f32 v[114:115], v[22:23], v[26:27], v[114:115]
    v_pk_fma_f32 v[108:109], v[76:77], v[32:33], v[108:109]
    v_pk_fma_f32 v[112:113], v[28:29], v[32:33], v[112:113]
    v_pk_fma_f32 v[110:111], v[78:79], v[34:35], v[110:111]
    v_pk_fma_f32 v[114:115], v[30:31], v[34:35], v[114:115]
    s_branch K2_BCG
K2_BND1G:
    s_waitcnt lgkmcnt(0)
    v_and_b32 v107, 0xffff0000, v93
    v_lshlrev_b32 v106, 16, v93
    v_and_b32 v105, 0xffff0000, v92
    v_lshlrev_b32 v104, 16, v92
    v_pk_add_f32 v[104:105], v[104:105], s[94:95] op_sel:[0,1] op_sel_hi:[1,1]
    v_pk_add_f32 v[106:107], v[106:107], s[94:95] op_sel:[0,1] op_sel_hi:[1,1]
    s_mov_b32 s37, 1
    s_waitcnt vmcnt(4)
    v_mfma_f32_16x16x16_bf16 v[72:75], v[86:87], v[94:95], v[104:107]
    v_rcp_f32 v40, v40
    v_mfma_f32_16x16x16_bf16 v[80:83], v[90:91], v[94:95], v[104:107]
    v_rcp_f32 v41, v41
    v_mfma_f32_16x16x32_bf16 v[72:75], v[16:19], v[56:59], v[72:75]
    v_rcp_f32 v42, v42
    v_mfma_f32_16x16x32_bf16 v[80:83], v[16:19], v[64:67], v[80:83]
    v_rcp_f32 v43, v43
    v_rcp_f32 v48, v48
    v_rcp_f32 v49, v49
    v_rcp_f32 v50, v50
    v_rcp_f32 v51, v51
    v_pk_fma_f32 v[108:109], v[68:69], v[40:41], v[108:109]
    v_pk_fma_f32 v[112:113], v[36:37], v[40:41], v[112:113]
    v_pk_fma_f32 v[110:111], v[70:71], v[42:43], v[110:111]
    v_pk_fma_f32 v[114:115], v[38:39], v[42:43], v[114:115]
    v_pk_fma_f32 v[108:109], v[76:77], v[48:49], v[108:109]
    v_pk_fma_f32 v[112:113], v[44:45], v[48:49], v[112:113]
    v_pk_fma_f32 v[110:111], v[78:79], v[50:51], v[110:111]
    v_pk_fma_f32 v[114:115], v[46:47], v[50:51], v[114:115]
    s_branch K2_BCG
K2_BND2G:
    s_waitcnt lgkmcnt(0)
    v_and_b32 v107, 0xffff0000, v93
    v_lshlrev_b32 v106, 16, v93
    v_and_b32 v105, 0xffff0000, v92
    v_lshlrev_b32 v104, 16, v92
    v_pk_add_f32 v[104:105], v[104:105], s[94:95] op_sel:[0,1] op_sel_hi:[1,1]
    v_pk_add_f32 v[106:107], v[106:107], s[94:95] op_sel:[0,1] op_sel_hi:[1,1]
    s_mov_b32 s37, 2
    s_waitcnt vmcnt(4)
    v_mfma_f32_16x16x16_bf16 v[72:75], v[86:87], v[94:95], v[104:107]
    v_rcp_f32 v56, v56
    v_mfma_f32_16x16x16_bf16 v[80:83], v[90:91], v[94:95], v[104:107]
    v_rcp_f32 v57, v57
    v_mfma_f32_16x16x32_bf16 v[72:75], v[16:19], v[24:27], v[72:75]
    v_rcp_f32 v58, v58
    v_mfma_f32_16x16x32_bf16 v[80:83], v[16:19], v[32:35], v[80:83]
    v_rcp_f32 v59, v59
    v_rcp_f32 v64, v64
    v_rcp_f32 v65, v65
    v_rcp_f32 v66, v66
    v_rcp_f32 v67, v67
    v_pk_fma_f32 v[108:109], v[68:69], v[56:57], v[108:109]
    v_pk_fma_f32 v[112:113], v[52:53], v[56:57], v[112:113]
    v_pk_fma_f32 v[110:111], v[70:71], v[58:59], v[110:111]
    v_pk_fma_f32 v[114:115], v[54:55], v[58:59], v[114:115]
    v_pk_fma_f32 v[108:109], v[76:77], v[64:65], v[108:109]
    v_pk_fma_f32 v[112:113], v[60:61], v[64:65], v[112:113]
    v_pk_fma_f32 v[110:111], v[78:79], v[66:67], v[110:111]
    v_pk_fma_f32 v[114:115], v[62:63], v[66:67], v[114:115]
K2_BCG:
    s_cmp_eq_u32 s46, 0
    s_cbranch_scc1 K2_WHOLE
    ds_add_f32 v6, v108 offset:0
    ds_add_f32 v6, v112 offset:25600
    ds_add_f32 v6, v109 offset:4
    ds_add_f32 v6, v113 offset:25604
    ds_add_f32 v6, v110 offset:8
    ds_add_f32 v6, v114 offset:25608
    ds_add_f32 v6, v111 offset:12
    ds_add_f32 v6, v115 offset:25612
    s_branch K2_NXTG
K2_WHOLE:
    ds_write_b128 v6, v[108:111]
    ds_write_b128 v6, v[112:115] offset:25600
K2_NXTG:
    s_cmp_ge_u32 s84, s85
    s_cbranch_scc1 K2_MAIN_ENDG
    s_add_u32 s86, s86, 1
    s_mov_b32 s92, s91
    v_readlane_b32 s91, v7, s86
    v_mov_b32 v122, v99
    s_mov_b32 s47, s84
    s_min_u32 s87, s91, s85
    s_cmp_lt_u32 s92, s84
    s_cselect_b32 s46, 1, 0
    s_cmp_gt_u32 s91, s85
    s_cselect_b32 s46, 1, s46
    v_mov_b32 v108, 0
    v_mov_b32 v109, 0
    v_mov_b32 v110, 0
    v_mov_b32 v111, 0
    v_mov_b32 v112, 0
    v_mov_b32 v113, 0
    v_mov_b32 v114, 0
    v_mov_b32 v115, 0
    v_xor_b32 v98, v97, v127
    v_add_u32 v99, v96, v127
    v_add_u32 v124, 32, v124
    ds_read_b64 v[92:93], v98
    ds_read_b64 v[96:97], v124 offset:2304
    v_add_u32 v6, 51968, v122
    v_add_u32 v6, v6, v127
    s_cmp_lg_u32 s46, 0
    s_cbranch_scc1 K2_SGBG
    ds_read_b128 v[108:111], v6
    ds_read_b128 v[112:115], v6 offset:25600
K2_SGBG:
    s_cmp_eq_u32 s37, 0
    s_cbranch_scc1 K2_STEP1G
    s_cmp_eq_u32 s37, 1
    s_cbranch_scc1 K2_STEP2G
    s_branch K2_STEP0G
K2_MAIN_ENDG:
    s_waitcnt vmcnt(0)
    v_lshrrev_b32 v5, 4, v0
    v_lshlrev_b32 v6, 8, v5
    v_lshl_add_u32 v6, v9, 3, v6
    s_lshl_b32 s98, s30, 8
    s_lshl_b32 s99, s28, 7
    s_add_u32 s98, s98, s99
    buffer_load_dwordx2 v[28:29], v6, s[48:51], s98 offen
    s_add_u32 s99, s98, 16384
    buffer_load_dwordx2 v[30:31], v6, s[48:51], s99 offen
    s_waitcnt lgkmcnt(0)
    s_barrier
    s_add_u32 s80, s80, s81
    s_cmp_lt_u32 s80, s82
    s_cbranch_scc1 K2_ROUND
    v_lshlrev_b32 v4, 4, v0
    v_add_u32 v4, 51968, v4
    v_and_b32 v10, 15, v5
    v_xor_b32 v10, v10, v0
    v_lshlrev_b32 v10, 3, v10
    v_add_u32 v10, 150272, v10
    v_min_u32 v11, 154872, v10
    ds_read_b128 v[32:35], v4 offset:0
    ds_read_b128 v[36:39], v4 offset:25600
    ds_read_b64 v[20:21], v10 offset:0
    ds_read_b128 v[40:43], v4 offset:16384
    ds_read_b128 v[44:47], v4 offset:41984
    ds_read_b64 v[24:25], v11 offset:8192
    s_mov_b32 s83, 0x498637bd
    s_waitcnt vmcnt(0) lgkmcnt(0)
    v_add_f32 v32, s83, v32
    v_add_f32 v33, s83, v33
    v_add_f32 v34, s83, v34
    v_add_f32 v35, s83, v35
    v_rcp_f32 v32, v32
    v_rcp_f32 v33, v33
    v_rcp_f32 v34, v34
    v_rcp_f32 v35, v35
    v_lshlrev_b32 v48, 16, v20
    v_fmac_f32 v48, v32, v36
    v_max_f32 v48, 0, v48
    v_lshlrev_b32 v14, 16, v28
    v_add_f32 v48, v14, v48
    v_and_b32 v49, 0xffff0000, v20
    v_fmac_f32 v49, v33, v37
    v_max_f32 v49, 0, v49
    v_and_b32 v14, 0xffff0000, v28
    v_add_f32 v49, v14, v49
    v_lshlrev_b32 v50, 16, v21
    v_fmac_f32 v50, v34, v38
    v_max_f32 v50, 0, v50
    v_lshlrev_b32 v14, 16, v29
    v_add_f32 v50, v14, v50
    v_and_b32 v51, 0xffff0000, v21
    v_fmac_f32 v51, v35, v39
    v_max_f32 v51, 0, v51
    v_and_b32 v14, 0xffff0000, v29
    v_add_f32 v51, v14, v51
    v_cvt_pk_bf16_f32 v52, v48, v49
    v_cvt_pk_bf16_f32 v53, v50, v51
    v_add_u32 v14, 0, v5
    v_cmp_gt_u32 vcc, s31, v14
    s_mov_b64 exec, vcc
    buffer_store_dwordx2 v[52:53], v6, s[52:55], s98 offen sc1
    s_mov_b64 exec, -1
    v_add_f32 v40, s83, v40
    v_add_f32 v41, s83, v41
    v_add_f32 v42, s83, v42
    v_add_f32 v43, s83, v43
    v_rcp_f32 v40, v40
    v_rcp_f32 v41, v41
    v_rcp_f32 v42, v42
    v_rcp_f32 v43, v43
    v_lshlrev_b32 v48, 16, v24
    v_fmac_f32 v48, v40, v44
    v_max_f32 v48, 0, v48
    v_lshlrev_b32 v14, 16, v30
    v_add_f32 v48, v14, v48
    v_and_b32 v49, 0xffff0000, v24
    v_fmac_f32 v49, v41, v45
    v_max_f32 v49, 0, v49
    v_and_b32 v14, 0xffff0000, v30
    v_add_f32 v49, v14, v49
    v_lshlrev_b32 v50, 16, v25
    v_fmac_f32 v50, v42, v46
    v_max_f32 v50, 0, v50
    v_lshlrev_b32 v14, 16, v31
    v_add_f32 v50, v14, v50
    v_and_b32 v51, 0xffff0000, v25
    v_fmac_f32 v51, v43, v47
    v_max_f32 v51, 0, v51
    v_and_b32 v14, 0xffff0000, v31
    v_add_f32 v51, v14, v51
    v_cvt_pk_bf16_f32 v54, v48, v49
    v_cvt_pk_bf16_f32 v55, v50, v51
    v_add_u32 v14, 64, v5
    v_cmp_gt_u32 vcc, s31, v14
    s_mov_b64 exec, vcc
    buffer_store_dwordx2 v[54:55], v6, s[52:55], s99 offen sc1
    s_mov_b64 exec, -1
K2_DONE:
KF_END:
    s_endpgm
.section .rodata,"a"
.p2align 6
.amdhsa_kernel gather_scatter__edge_featured_mpnn_gatedgcn__graph_kernel
  .amdhsa_next_free_vgpr 128
  .amdhsa_next_free_sgpr 102
  .amdhsa_accum_offset 128
  .amdhsa_group_segment_fixed_size 0
  .amdhsa_kernarg_size 96
  .amdhsa_user_sgpr_count 2
  .amdhsa_user_sgpr_kernarg_segment_ptr 1
  .amdhsa_system_sgpr_workgroup_id_x 1
.end_amdhsa_kernel
```
